```python
import torch

def _softmax(x, axis=-1):
    return torch.softmax(x, dim=axis)
def _gelu(x):
    return torch.nn.functional.gelu(x, approximate="tanh")
def _silu(x):
    return torch.nn.functional.silu(x)
def _sigmoid(x):
    return torch.sigmoid(x)
def _layernorm(x, axis=-1, eps=1e-5):
    m = x.mean(dim=axis, keepdim=True)
    v = x.var(dim=axis, keepdim=True, unbiased=False)
    return (x - m) / torch.sqrt(v + eps)
def _scatter_add(tgt, idx, src, axis=0):
    return tgt.clone().index_add_(axis, idx, src)
def _segment_sum(src, seg, n):
    out = torch.zeros((n,) + src.shape[1:], dtype=src.dtype)
    return out.index_add_(0, seg, src)
def _pad(x, pw):
    flat = tuple(v for pair in reversed(pw) for v in pair)
    return torch.nn.functional.pad(x, flat)

kernel_name = 'standalone__gqa_softmax__near_ridge'

def setup_inputs():

    _w = (lambda a: (lambda t: t.to(torch.bfloat16) if t.is_floating_point() else t)(torch.as_tensor(a)))
    B, Hq, Hkv, Sq, Sk, D = 32, 32, 8, 64, 512, 128
    return {
        "q": _w((lambda *s: torch.randn(*s, dtype=torch.bfloat16) * 0.8)(B, Hq, Sq, D)),
        "k": _w((lambda *s: torch.randn(*s, dtype=torch.bfloat16) * 0.8)(B, Hkv, Sk, D)),
        "v": _w((lambda *s: torch.randn(*s, dtype=torch.bfloat16) * 0.05)(B, Hkv, Sk, D)),
    }

def reference(q, k, v):
    B, Hq, Sq, D = q.shape
    Hkv = k.shape[1]
    rep = Hq // Hkv
    k = (lambda x, n, axis: torch.repeat_interleave(x, n, dim=axis))(k, rep, axis=1)
    v = (lambda x, n, axis: torch.repeat_interleave(x, n, dim=axis))(v, rep, axis=1)
    scale = D ** -0.5
    scores = torch.einsum("bhqd,bhkd->bhqk", q, k) * scale
    p = _softmax(scores, axis=-1)
    return torch.einsum("bhqk,bhkd->bhqd", p, v)
```

```asm
; @launch grid=(256,1,1) block=(256,1,1) lds=163840
.amdgcn_target "amdgcn-amd-amdhsa--gfx950"
.text
.globl standalone__gqa_softmax__near_ridge_kernel
.p2align 8
.type standalone__gqa_softmax__near_ridge_kernel,@function
standalone__gqa_softmax__near_ridge_kernel:
    s_load_dwordx8 s[4:11], s[0:1], 0
    s_cmp_ge_u32 s2, 256
    s_cbranch_scc1 L_end
    s_getpc_b64 s[40:41]
L_pc:
    v_lshlrev_b32 v1, 7, v0
    v_min_u32 v1, L_end-L_pc, v1
    global_load_dword v47, v1, s[40:41]
    s_and_b32 s36, s2, 7
    s_lshr_b32 s2, s2, 3
    s_lshl_b32 s36, s36, 5
    s_add_u32 s2, s2, s36
    v_lshrrev_b32 v1, 6, v0
    v_and_b32 v25, 63, v0
    v_readfirstlane_b32 s3, v1
    v_lshrrev_b32 v2, 4, v25
    v_and_b32 v3, 15, v25
    v_xor_b32 v4, v2, v3
    v_lshlrev_b32 v4, 4, v4
    v_lshl_add_u32 v24, v2, 8, v4
    v_lshl_add_u32 v8, v3, 8, v4
    v_xor_b32 v5, 64, v24
    v_xor_b32 v6, 128, v24
    v_xor_b32 v7, 192, v24
    s_and_b32 s39, s3, 1
    s_lshl_b32 s39, s39, 7
    v_xor_b32 v20, s39, v24
    v_xor_b32 v21, 64, v20
    v_lshlrev_b32 v4, 1, v2
    v_xor_b32 v4, v4, v3
    v_lshlrev_b32 v4, 4, v4
    v_lshl_add_u32 v22, v2, 8, v4
    v_xor_b32 v23, 0x80, v22
    s_lshl_b32 s37, s3, 14
    s_add_u32 s16, s37, 98304
    s_lshl_b32 s36, s2, 16
    s_add_u32 s36, s36, s37
    s_lshl_b32 s38, s36, 1
    s_lshl_b32 s14, s3, 11
    s_add_u32 s15, s14, 49152
    s_mov_b32 s27, 0x20000
    s_mov_b32 s23, 0x20000
    s_mov_b32 s31, 0x20000
    s_mov_b32 s35, 0x20000
    s_bfe_u32 s39, s2, 65536
    s_lshl_b32 s42, s39, 11
    s_bfe_u32 s39, s2, 65537
    s_lshl_b32 s39, s39, 13
    s_xor_b32 s42, s42, s39
    s_bfe_u32 s39, s2, 65537
    s_lshl_b32 s43, s39, 12
    s_bfe_u32 s39, s2, 65538
    s_lshl_b32 s39, s39, 13
    s_xor_b32 s43, s43, s39
    s_waitcnt lgkmcnt(0)
    s_add_u32 s65, s6, s38
    s_addc_u32 s25, s7, 0
    s_and_b32 s39, s65, 32767
    s_xor_b32 s65, s65, s39
    s_xor_b32 s65, s65, s42
    s_add_u32 s26, s39, 2048
    v_add_u32 v20, s39, v20
    v_add_u32 v21, s39, v21
    s_add_u32 m0, s14, 0
    s_xor_b32 s24, s65, 0
    buffer_load_dwordx4 v20, s[24:27], 0 offen offset:0 nt lds
    buffer_load_dwordx4 v21, s[24:27], 0 offen offset:1024 nt lds
    s_add_u32 s64, s4, s36
    s_addc_u32 s21, s5, 0
    s_and_b32 s39, s64, 16383
    s_xor_b32 s64, s64, s39
    s_xor_b32 s64, s64, s43
    s_add_u32 s22, s39, 4096
    v_add_u32 v24, s39, v24
    v_add_u32 v5, s39, v5
    v_add_u32 v6, s39, v6
    v_add_u32 v7, s39, v7
    s_add_u32 m0, s16, 0
    s_xor_b32 s20, s64, 0
    buffer_load_dwordx4 v24, s[20:23], 0 offen offset:0 nt lds
    buffer_load_dwordx4 v5, s[20:23], 0 offen offset:1024 nt lds
    buffer_load_dwordx4 v6, s[20:23], 0 offen offset:2048 nt lds
    buffer_load_dwordx4 v7, s[20:23], 0 offen offset:3072 nt lds
    s_add_u32 s66, s8, s38
    s_addc_u32 s29, s9, 0
    s_and_b32 s39, s66, 32767
    s_xor_b32 s66, s66, s39
    s_xor_b32 s66, s66, s42
    s_add_u32 s30, s39, 2048
    v_add_u32 v22, s39, v22
    v_add_u32 v23, s39, v23
    s_add_u32 m0, s15, 0
    s_xor_b32 s28, s66, 0
    buffer_load_dwordx4 v22, s[28:31], 0 offen offset:0 nt lds
    buffer_load_dwordx4 v23, s[28:31], 0 offen offset:1024 nt lds
    s_add_u32 m0, s16, 4096
    s_xor_b32 s20, s64, 4096
    buffer_load_dwordx4 v24, s[20:23], 0 offen offset:0 nt lds
    buffer_load_dwordx4 v5, s[20:23], 0 offen offset:1024 nt lds
    s_mov_b32 s17, 0x3e0293ee
    s_mov_b32 s18, 0xffff0000
    s_mov_b32 s19, 0x53800000
    v_xor_b32 v9, 64, v8
    v_xor_b32 v10, 128, v8
    v_xor_b32 v11, 192, v8
    v_add_u32 v120, s16, v8
    v_add_u32 v121, s16, v9
    v_add_u32 v122, s16, v10
    v_add_u32 v123, s16, v11
    v_lshrrev_b32 v1, 2, v25
    v_and_b32 v4, 7, v1
    v_lshlrev_b32 v4, 5, v4
    v_lshl_add_u32 v4, v1, 8, v4
    v_and_b32 v1, 3, v25
    v_lshl_add_u32 v4, v1, 3, v4
    v_add_u32 v12, 49152, v4
    v_xor_b32 v13, 32, v12
    v_xor_b32 v14, 64, v12
    v_xor_b32 v15, 96, v12
    v_xor_b32 v16, 128, v12
    v_xor_b32 v17, 160, v12
    v_xor_b32 v18, 192, v12
    v_xor_b32 v19, 224, v12
    v_mul_u32_u24 v1, 136, v3
    v_lshl_add_u32 v1, v2, 3, v1
    v_add_u32 v40, s16, v1
    v_add_u32 v41, 2176, v40
    v_lshrrev_b32 v1, 3, v25
    v_and_b32 v4, 7, v25
    v_lshlrev_b32 v4, 4, v4
    v_lshl_add_u32 v44, v1, 8, v4
    v_mul_u32_u24 v1, 136, v1
    v_add3_u32 v42, v1, v4, s16
    v_add_u32 v43, 2176, v42
    s_add_u32 s67, s10, s36
    s_addc_u32 s33, s11, 0
    s_and_b32 s39, s67, 16383
    s_xor_b32 s67, s67, s39
    s_xor_b32 s67, s67, s43
    s_add_u32 s34, s39, 4096
    v_add_u32 v44, s39, v44
    s_xor_b32 s32, s67, 0
    v_mov_b32 v34, s17
    v_bfe_u32 v1, v25, 1, 1
    v_lshrrev_b32 v4, 5, v25
    v_cmp_eq_u32 vcc, v4, v1
    v_mov_b32 v4, 0x3f803f80
    v_mul_lo_u32 v108, v1, v4
    v_and_b32 v1, 1, v25
    v_cndmask_b32 v112, 0, v4, vcc
    v_xor_b32 v104, v4, v108
    v_mov_b32 v113, v112
    v_mov_b32 v105, v104
    v_mov_b32 v109, v108
    v_mov_b32 v114, v112
    v_mov_b32 v106, v104
    v_mov_b32 v110, v108
    v_mov_b32 v115, v112
    v_mov_b32 v107, v104
    v_mov_b32 v111, v108
    v_mul_u32_u24 v1, 0xaaaa, v1
    v_xor_b32 v116, 0x4444, v1
    v_mov_b32 v96, 0
    v_mov_b32 v97, 0
    v_mov_b32 v98, 0
    v_mov_b32 v99, 0
    v_mov_b32 v100, 0
    v_mov_b32 v101, 0
    v_mov_b32 v102, 0
    v_mov_b32 v103, 0
    v_mov_b32 v124, 0
    v_mov_b32 v125, 0
    v_mov_b32 v126, 0
    v_mov_b32 v127, 0
    s_branch L_main
    .p2align 12
L_main:
    s_waitcnt vmcnt(8)
    s_mov_b64 exec, 0
    s_cmp_eq_u32 s3, 0
    s_cbranch_scc1 L_hop0
    s_cmp_eq_u32 s3, 1
    s_cbranch_scc1 L_hop1
    s_cmp_eq_u32 s3, 2
    s_cbranch_scc1 L_hop2
    s_branch L_hop3
L_hop_back:
    s_mov_b64 exec, -1
    s_waitcnt vmcnt(6)
    buffer_load_dwordx4 v6, s[20:23], 0 offen offset:2048 nt lds
    buffer_load_dwordx4 v7, s[20:23], 0 offen offset:3072 nt lds
    s_waitcnt vmcnt(6)
    s_barrier
    ds_read_b128 v[128:131], v120 offset:0
    ds_read_b128 v[132:135], v121 offset:0
    ds_read_b128 v[136:139], v122 offset:0
    ds_read_b128 v[140:143], v123 offset:0
    ds_read_b128 a[64:67], v8 offset:0
    ds_read_b128 a[68:71], v9 offset:0
    ds_read_b128 a[72:75], v10 offset:0
    ds_read_b128 a[76:79], v11 offset:0
    ds_read_b128 a[80:83], v8 offset:4096
    ds_read_b128 a[84:87], v9 offset:4096
    ds_read_b128 a[88:91], v10 offset:4096
    ds_read_b128 a[92:95], v11 offset:4096
    s_add_u32 m0, s14, 8192
    s_xor_b32 s24, s65, 2048
    buffer_load_dwordx4 v20, s[24:27], 0 offen offset:0 nt lds
    buffer_load_dwordx4 v21, s[24:27], 0 offen offset:1024 nt lds
    s_waitcnt lgkmcnt(11)
    v_lshlrev_b32 v144, 16, v128
    v_and_b32 v145, s18, v128
    v_lshlrev_b32 v146, 16, v129
    v_and_b32 v147, s18, v129
    v_lshlrev_b32 v148, 16, v130
    v_and_b32 v149, s18, v130
    v_lshlrev_b32 v150, 16, v131
    v_and_b32 v151, s18, v131
    v_pk_mul_f32 v[144:145], v[144:145], v[34:35] op_sel_hi:[1,0]
    v_pk_mul_f32 v[146:147], v[146:147], v[34:35] op_sel_hi:[1,0]
    v_pk_mul_f32 v[148:149], v[148:149], v[34:35] op_sel_hi:[1,0]
    v_pk_mul_f32 v[150:151], v[150:151], v[34:35] op_sel_hi:[1,0]
    v_cvt_pk_bf16_f32 v144, v144, v145
    v_cvt_pk_bf16_f32 v145, v146, v147
    v_cvt_pk_bf16_f32 v146, v148, v149
    v_cvt_pk_bf16_f32 v147, v150, v151
    v_accvgpr_write_b32 a0, v144
    v_accvgpr_write_b32 a1, v145
    v_accvgpr_write_b32 a2, v146
    v_accvgpr_write_b32 a3, v147
    s_waitcnt lgkmcnt(0)
    v_lshlrev_b32 v152, 16, v132
    v_and_b32 v153, s18, v132
    v_lshlrev_b32 v154, 16, v133
    v_and_b32 v155, s18, v133
    v_lshlrev_b32 v156, 16, v134
    v_and_b32 v157, s18, v134
    v_lshlrev_b32 v158, 16, v135
    v_and_b32 v159, s18, v135
    v_pk_mul_f32 v[152:153], v[152:153], v[34:35] op_sel_hi:[1,0]
    v_pk_mul_f32 v[154:155], v[154:155], v[34:35] op_sel_hi:[1,0]
    v_pk_mul_f32 v[156:157], v[156:157], v[34:35] op_sel_hi:[1,0]
    v_pk_mul_f32 v[158:159], v[158:159], v[34:35] op_sel_hi:[1,0]
    v_cvt_pk_bf16_f32 v152, v152, v153
    v_cvt_pk_bf16_f32 v153, v154, v155
    v_cvt_pk_bf16_f32 v154, v156, v157
    v_cvt_pk_bf16_f32 v155, v158, v159
    v_accvgpr_write_b32 a4, v152
    v_accvgpr_write_b32 a5, v153
    v_accvgpr_write_b32 a6, v154
    v_accvgpr_write_b32 a7, v155
    v_lshlrev_b32 v144, 16, v136
    v_and_b32 v145, s18, v136
    v_lshlrev_b32 v146, 16, v137
    v_and_b32 v147, s18, v137
    v_lshlrev_b32 v148, 16, v138
    v_and_b32 v149, s18, v138
    v_lshlrev_b32 v150, 16, v139
    v_and_b32 v151, s18, v139
    v_pk_mul_f32 v[144:145], v[144:145], v[34:35] op_sel_hi:[1,0]
    v_pk_mul_f32 v[146:147], v[146:147], v[34:35] op_sel_hi:[1,0]
    v_pk_mul_f32 v[148:149], v[148:149], v[34:35] op_sel_hi:[1,0]
    v_pk_mul_f32 v[150:151], v[150:151], v[34:35] op_sel_hi:[1,0]
    v_cvt_pk_bf16_f32 v144, v144, v145
    v_cvt_pk_bf16_f32 v145, v146, v147
    v_cvt_pk_bf16_f32 v146, v148, v149
    v_cvt_pk_bf16_f32 v147, v150, v151
    v_accvgpr_write_b32 a8, v144
    v_accvgpr_write_b32 a9, v145
    v_accvgpr_write_b32 a10, v146
    v_accvgpr_write_b32 a11, v147
    v_lshlrev_b32 v152, 16, v140
    v_and_b32 v153, s18, v140
    v_lshlrev_b32 v154, 16, v141
    v_and_b32 v155, s18, v141
    v_lshlrev_b32 v156, 16, v142
    v_and_b32 v157, s18, v142
    v_lshlrev_b32 v158, 16, v143
    v_and_b32 v159, s18, v143
    v_pk_mul_f32 v[152:153], v[152:153], v[34:35] op_sel_hi:[1,0]
    v_pk_mul_f32 v[154:155], v[154:155], v[34:35] op_sel_hi:[1,0]
    v_pk_mul_f32 v[156:157], v[156:157], v[34:35] op_sel_hi:[1,0]
    v_pk_mul_f32 v[158:159], v[158:159], v[34:35] op_sel_hi:[1,0]
    v_cvt_pk_bf16_f32 v152, v152, v153
    v_cvt_pk_bf16_f32 v153, v154, v155
    v_cvt_pk_bf16_f32 v154, v156, v157
    v_cvt_pk_bf16_f32 v155, v158, v159
    v_accvgpr_write_b32 a12, v152
    v_accvgpr_write_b32 a13, v153
    v_accvgpr_write_b32 a14, v154
    v_accvgpr_write_b32 a15, v155
    v_mfma_f32_16x16x32_bf16 v[64:67], a[64:67], a[0:3], 0
    v_mfma_f32_16x16x32_bf16 v[64:67], a[68:71], a[4:7], v[64:67]
    v_mfma_f32_16x16x32_bf16 v[64:67], a[72:75], a[8:11], v[64:67]
    v_mfma_f32_16x16x32_bf16 v[64:67], a[76:79], a[12:15], v[64:67]
    v_mfma_f32_16x16x32_bf16 v[68:71], a[80:83], a[0:3], 0
    v_mfma_f32_16x16x32_bf16 v[68:71], a[84:87], a[4:7], v[68:71]
    v_mfma_f32_16x16x32_bf16 v[68:71], a[88:91], a[8:11], v[68:71]
    v_mfma_f32_16x16x32_bf16 v[68:71], a[92:95], a[12:15], v[68:71]
    s_waitcnt vmcnt(6)
    s_barrier
    ds_read_b64_tr_b16 a[128:129], v12 offset:0
    ds_read_b64_tr_b16 a[130:131], v12 offset:4096
    ds_read_b64_tr_b16 a[132:133], v13 offset:0
    ds_read_b64_tr_b16 a[134:135], v13 offset:4096
    ds_read_b64_tr_b16 a[136:137], v14 offset:0
    ds_read_b64_tr_b16 a[138:139], v14 offset:4096
    ds_read_b64_tr_b16 a[140:141], v15 offset:0
    ds_read_b64_tr_b16 a[142:143], v15 offset:4096
    ds_read_b64_tr_b16 a[144:145], v16 offset:0
    ds_read_b64_tr_b16 a[146:147], v16 offset:4096
    ds_read_b64_tr_b16 a[148:149], v17 offset:0
    ds_read_b64_tr_b16 a[150:151], v17 offset:4096
    ds_read_b64_tr_b16 a[152:153], v18 offset:0
    ds_read_b64_tr_b16 a[154:155], v18 offset:4096
    ds_read_b64_tr_b16 a[156:157], v19 offset:0
    ds_read_b64_tr_b16 a[158:159], v19 offset:4096
    v_max3_f32 v30, v64, v65, v66
    v_max3_f32 v30, v30, v67, v68
    v_max3_f32 v30, v30, v69, v70
    v_max_f32 v30, v30, v71
    v_mov_b32 v31, v30
    s_nop 1
    v_permlane16_swap_b32 v30, v31
    v_max_f32 v30, v30, v31
    v_mov_b32 v31, v30
    s_nop 1
    v_permlane32_swap_b32 v30, v31
    v_max_f32 v30, v30, v31
    v_sub_f32 v48, 0, v30
    v_sub_f32 v49, 0, v30
    v_sub_f32 v50, 0, v30
    v_sub_f32 v51, 0, v30
    v_add_f32 v64, v48, v64
    v_exp_f32 v64, v64
    v_add_f32 v65, v48, v65
    v_exp_f32 v65, v65
    v_add_f32 v66, v48, v66
    v_exp_f32 v66, v66
    v_add_f32 v67, v48, v67
    v_cvt_pk_bf16_f32 v80, v64, v65
    v_exp_f32 v67, v67
    v_add_f32 v68, v48, v68
    v_exp_f32 v68, v68
    v_add_f32 v69, v48, v69
    v_cvt_pk_bf16_f32 v81, v66, v67
    v_exp_f32 v69, v69
    v_add_f32 v70, v48, v70
    v_exp_f32 v70, v70
    v_add_f32 v71, v48, v71
    v_cvt_pk_bf16_f32 v82, v68, v69
    v_exp_f32 v71, v71
    s_nop 0
    v_cvt_pk_bf16_f32 v83, v70, v71
    s_waitcnt lgkmcnt(0)
    s_nop 0
    v_mfma_f32_16x16x32_bf16 v[128:131], a[128:131], v[80:83], 0
    v_mfma_f32_16x16x32_bf16 v[132:135], a[132:135], v[80:83], 0
    v_mfma_f32_16x16x32_bf16 v[136:139], a[136:139], v[80:83], 0
    v_mfma_f32_16x16x32_bf16 v[140:143], a[140:143], v[80:83], 0
    v_mfma_f32_16x16x32_bf16 v[144:147], a[144:147], v[80:83], 0
    v_mfma_f32_16x16x32_bf16 v[148:151], a[148:151], v[80:83], 0
    v_mfma_f32_16x16x32_bf16 v[152:155], a[152:155], v[80:83], 0
    v_mfma_f32_16x16x32_bf16 v[156:159], a[156:159], v[80:83], 0
    s_waitcnt vmcnt(4)
    s_add_u32 m0, s15, 8192
    s_xor_b32 s28, s66, 2048
    buffer_load_dwordx4 v22, s[28:31], 0 offen offset:0 nt lds
    buffer_load_dwordx4 v23, s[28:31], 0 offen offset:1024 nt lds
    s_waitcnt vmcnt(4)
    ds_read_b128 v[160:163], v120 offset:4096
    ds_read_b128 v[164:167], v121 offset:4096
    ds_read_b128 v[168:171], v122 offset:4096
    ds_read_b128 v[172:175], v123 offset:4096
    s_add_u32 m0, s16, 8192
    s_xor_b32 s20, s64, 8192
    buffer_load_dwordx4 v24, s[20:23], 0 offen offset:0 nt lds
    buffer_load_dwordx4 v5, s[20:23], 0 offen offset:1024 nt lds
    s_waitcnt lgkmcnt(3)
    v_lshlrev_b32 v176, 16, v160
    v_and_b32 v177, s18, v160
    v_lshlrev_b32 v178, 16, v161
    v_and_b32 v179, s18, v161
    v_lshlrev_b32 v180, 16, v162
    v_and_b32 v181, s18, v162
    v_lshlrev_b32 v182, 16, v163
    v_and_b32 v183, s18, v163
    v_pk_mul_f32 v[176:177], v[176:177], v[34:35] op_sel_hi:[1,0]
    v_pk_mul_f32 v[178:179], v[178:179], v[34:35] op_sel_hi:[1,0]
    v_pk_mul_f32 v[180:181], v[180:181], v[34:35] op_sel_hi:[1,0]
    v_pk_mul_f32 v[182:183], v[182:183], v[34:35] op_sel_hi:[1,0]
    v_cvt_pk_bf16_f32 v176, v176, v177
    v_cvt_pk_bf16_f32 v177, v178, v179
    v_cvt_pk_bf16_f32 v178, v180, v181
    v_cvt_pk_bf16_f32 v179, v182, v183
    v_accvgpr_write_b32 a16, v176
    v_accvgpr_write_b32 a17, v177
    v_accvgpr_write_b32 a18, v178
    v_accvgpr_write_b32 a19, v179
    s_waitcnt lgkmcnt(0)
    v_lshlrev_b32 v184, 16, v164
    v_and_b32 v185, s18, v164
    v_lshlrev_b32 v186, 16, v165
    v_and_b32 v187, s18, v165
    v_lshlrev_b32 v188, 16, v166
    v_and_b32 v189, s18, v166
    v_lshlrev_b32 v190, 16, v167
    v_and_b32 v191, s18, v167
    v_pk_mul_f32 v[184:185], v[184:185], v[34:35] op_sel_hi:[1,0]
    v_pk_mul_f32 v[186:187], v[186:187], v[34:35] op_sel_hi:[1,0]
    v_pk_mul_f32 v[188:189], v[188:189], v[34:35] op_sel_hi:[1,0]
    v_pk_mul_f32 v[190:191], v[190:191], v[34:35] op_sel_hi:[1,0]
    v_cvt_pk_bf16_f32 v184, v184, v185
    v_cvt_pk_bf16_f32 v185, v186, v187
    v_cvt_pk_bf16_f32 v186, v188, v189
    v_cvt_pk_bf16_f32 v187, v190, v191
    v_accvgpr_write_b32 a20, v184
    v_accvgpr_write_b32 a21, v185
    v_accvgpr_write_b32 a22, v186
    v_accvgpr_write_b32 a23, v187
    v_lshlrev_b32 v176, 16, v168
    v_and_b32 v177, s18, v168
    v_lshlrev_b32 v178, 16, v169
    v_and_b32 v179, s18, v169
    v_lshlrev_b32 v180, 16, v170
    v_and_b32 v181, s18, v170
    v_lshlrev_b32 v182, 16, v171
    v_and_b32 v183, s18, v171
    v_pk_mul_f32 v[176:177], v[176:177], v[34:35] op_sel_hi:[1,0]
    v_pk_mul_f32 v[178:179], v[178:179], v[34:35] op_sel_hi:[1,0]
    v_pk_mul_f32 v[180:181], v[180:181], v[34:35] op_sel_hi:[1,0]
    v_pk_mul_f32 v[182:183], v[182:183], v[34:35] op_sel_hi:[1,0]
    v_cvt_pk_bf16_f32 v176, v176, v177
    v_cvt_pk_bf16_f32 v177, v178, v179
    v_cvt_pk_bf16_f32 v178, v180, v181
    v_cvt_pk_bf16_f32 v179, v182, v183
    v_accvgpr_write_b32 a24, v176
    v_accvgpr_write_b32 a25, v177
    v_accvgpr_write_b32 a26, v178
    v_accvgpr_write_b32 a27, v179
    v_lshlrev_b32 v184, 16, v172
    v_and_b32 v185, s18, v172
    v_lshlrev_b32 v186, 16, v173
    v_and_b32 v187, s18, v173
    v_lshlrev_b32 v188, 16, v174
    v_and_b32 v189, s18, v174
    v_lshlrev_b32 v190, 16, v175
    v_and_b32 v191, s18, v175
    v_pk_mul_f32 v[184:185], v[184:185], v[34:35] op_sel_hi:[1,0]
    v_pk_mul_f32 v[186:187], v[186:187], v[34:35] op_sel_hi:[1,0]
    v_pk_mul_f32 v[188:189], v[188:189], v[34:35] op_sel_hi:[1,0]
    v_pk_mul_f32 v[190:191], v[190:191], v[34:35] op_sel_hi:[1,0]
    v_cvt_pk_bf16_f32 v184, v184, v185
    v_cvt_pk_bf16_f32 v185, v186, v187
    v_cvt_pk_bf16_f32 v186, v188, v189
    v_cvt_pk_bf16_f32 v187, v190, v191
    v_accvgpr_write_b32 a28, v184
    v_accvgpr_write_b32 a29, v185
    v_accvgpr_write_b32 a30, v186
    v_accvgpr_write_b32 a31, v187
    v_mfma_f32_16x16x32_bf16 v[72:75], a[64:67], a[16:19], 0
    v_mfma_f32_16x16x32_bf16 v[72:75], a[68:71], a[20:23], v[72:75]
    v_mfma_f32_16x16x32_bf16 v[72:75], a[72:75], a[24:27], v[72:75]
    v_mfma_f32_16x16x32_bf16 v[72:75], a[76:79], a[28:31], v[72:75]
    v_mfma_f32_16x16x32_bf16 v[76:79], a[80:83], a[16:19], 0
    v_mfma_f32_16x16x32_bf16 v[76:79], a[84:87], a[20:23], v[76:79]
    v_mfma_f32_16x16x32_bf16 v[76:79], a[88:91], a[24:27], v[76:79]
    v_mfma_f32_16x16x32_bf16 v[76:79], a[92:95], a[28:31], v[76:79]
    s_waitcnt vmcnt(4)
    s_barrier
    ds_read_b128 a[96:99], v8 offset:8192
    ds_read_b128 a[100:103], v9 offset:8192
    ds_read_b128 a[104:107], v10 offset:8192
    ds_read_b128 a[108:111], v11 offset:8192
    ds_read_b128 a[112:115], v8 offset:12288
    ds_read_b128 a[116:119], v9 offset:12288
    ds_read_b128 a[120:123], v10 offset:12288
    ds_read_b128 a[124:127], v11 offset:12288
    buffer_load_dwordx4 v6, s[20:23], 0 offen offset:2048 nt lds
    buffer_load_dwordx4 v7, s[20:23], 0 offen offset:3072 nt lds
    v_max3_f32 v30, v72, v73, v74
    v_max3_f32 v30, v30, v75, v76
    v_max3_f32 v30, v30, v77, v78
    v_max_f32 v30, v30, v79
    v_mov_b32 v31, v30
    s_nop 1
    v_permlane16_swap_b32 v30, v31
    v_max_f32 v30, v30, v31
    v_mov_b32 v31, v30
    s_nop 1
    v_permlane32_swap_b32 v30, v31
    v_max_f32 v30, v30, v31
    v_sub_f32 v52, 0, v30
    v_sub_f32 v53, 0, v30
    v_sub_f32 v54, 0, v30
    v_sub_f32 v55, 0, v30
    v_add_f32 v72, v52, v72
    v_exp_f32 v72, v72
    v_add_f32 v73, v52, v73
    v_exp_f32 v73, v73
    v_add_f32 v74, v52, v74
    s_waitcnt lgkmcnt(1)
    v_mfma_f32_16x16x32_bf16 v[64:67], a[96:99], a[0:3], v[48:51]
    v_exp_f32 v74, v74
    v_add_f32 v75, v52, v75
    v_cvt_pk_bf16_f32 v84, v72, v73
    v_mfma_f32_16x16x32_bf16 v[64:67], a[100:103], a[4:7], v[64:67]
    v_exp_f32 v75, v75
    v_add_f32 v76, v52, v76
    v_mfma_f32_16x16x32_bf16 v[64:67], a[104:107], a[8:11], v[64:67]
    v_exp_f32 v76, v76
    v_add_f32 v77, v52, v77
    v_cvt_pk_bf16_f32 v85, v74, v75
    v_mfma_f32_16x16x32_bf16 v[64:67], a[108:111], a[12:15], v[64:67]
    v_exp_f32 v77, v77
    v_add_f32 v78, v52, v78
    v_mfma_f32_16x16x32_bf16 v[68:71], a[112:115], a[0:3], v[48:51]
    v_exp_f32 v78, v78
    v_add_f32 v79, v52, v79
    v_cvt_pk_bf16_f32 v86, v76, v77
    v_mfma_f32_16x16x32_bf16 v[68:71], a[116:119], a[4:7], v[68:71]
    v_exp_f32 v79, v79
    v_mfma_f32_16x16x32_bf16 v[68:71], a[120:123], a[8:11], v[68:71]
    s_waitcnt lgkmcnt(0)
    v_cvt_pk_bf16_f32 v87, v78, v79
    v_mfma_f32_16x16x32_bf16 v[68:71], a[124:127], a[12:15], v[68:71]
    v_exp_f32 v64, v64
    v_mfma_f32_16x16x32_bf16 v[160:163], a[128:131], v[84:87], 0
    v_mfma_f32_16x16x32_bf16 v[164:167], a[132:135], v[84:87], 0
    v_exp_f32 v65, v65
    v_mfma_f32_16x16x32_bf16 v[168:171], a[136:139], v[84:87], 0
    v_cvt_pk_bf16_f32 v88, v64, v65
    v_mfma_f32_16x16x32_bf16 v[172:175], a[140:143], v[84:87], 0
    v_exp_f32 v66, v66
    v_smfmac_f32_16x16x64_bf16 v[96:99], v[112:115], v[80:87], v116
    v_mfma_f32_16x16x32_bf16 v[176:179], a[144:147], v[84:87], 0
    v_mfma_f32_16x16x32_bf16 v[180:183], a[148:151], v[84:87], 0
    v_exp_f32 v67, v67
    v_mfma_f32_16x16x32_bf16 v[184:187], a[152:155], v[84:87], 0
    v_cvt_pk_bf16_f32 v89, v66, v67
    v_mfma_f32_16x16x32_bf16 v[188:191], a[156:159], v[84:87], 0
    s_waitcnt vmcnt(4)
    v_exp_f32 v68, v68
    v_mfma_f32_16x16x32_bf16 v[72:75], a[96:99], a[16:19], v[52:55]
    s_barrier
    ds_read_b64_tr_b16 a[160:161], v12 offset:8192
    v_mfma_f32_16x16x32_bf16 v[72:75], a[100:103], a[20:23], v[72:75]
    ds_read_b64_tr_b16 a[162:163], v12 offset:12288
    ds_read_b64_tr_b16 a[164:165], v13 offset:8192
    v_exp_f32 v69, v69
    v_mfma_f32_16x16x32_bf16 v[72:75], a[104:107], a[24:27], v[72:75]
    s_add_u32 m0, s14, 16384
    ds_read_b64_tr_b16 a[166:167], v13 offset:12288
    v_cvt_pk_bf16_f32 v90, v68, v69
    v_mfma_f32_16x16x32_bf16 v[72:75], a[108:111], a[28:31], v[72:75]
    s_xor_b32 s24, s65, 4096
    buffer_load_dwordx4 v20, s[24:27], 0 offen offset:0 nt lds
    ds_read_b64_tr_b16 a[168:169], v14 offset:8192
    v_exp_f32 v70, v70
    v_mfma_f32_16x16x32_bf16 v[76:79], a[112:115], a[16:19], v[52:55]
    ds_read_b64_tr_b16 a[170:171], v14 offset:12288
    ds_read_b64_tr_b16 a[172:173], v15 offset:8192
    v_mfma_f32_16x16x32_bf16 v[76:79], a[116:119], a[20:23], v[76:79]
    ds_read_b64_tr_b16 a[174:175], v15 offset:12288
    ds_read_b64_tr_b16 a[176:177], v16 offset:8192
    v_exp_f32 v71, v71
    v_mfma_f32_16x16x32_bf16 v[76:79], a[120:123], a[24:27], v[76:79]
    ds_read_b64_tr_b16 a[178:179], v16 offset:12288
    v_cvt_pk_bf16_f32 v91, v70, v71
    v_mfma_f32_16x16x32_bf16 v[76:79], a[124:127], a[28:31], v[76:79]
    s_waitcnt lgkmcnt(7)
    ds_read_b64_tr_b16 a[180:181], v17 offset:8192
    v_exp_f32 v72, v72
    v_mfma_f32_16x16x32_bf16 v[128:131], a[160:163], v[88:91], v[128:131]
    s_waitcnt lgkmcnt(7)
    ds_read_b64_tr_b16 a[182:183], v17 offset:12288
    buffer_load_dwordx4 v21, s[24:27], 0 offen offset:1024 nt lds
    v_exp_f32 v73, v73
    v_mfma_f32_16x16x32_bf16 v[132:135], a[164:167], v[88:91], v[132:135]
    s_waitcnt lgkmcnt(6)
    ds_read_b64_tr_b16 a[184:185], v18 offset:8192
    ds_read_b64_tr_b16 a[186:187], v18 offset:12288
    v_exp_f32 v74, v74
    v_cvt_pk_bf16_f32 v92, v72, v73
    v_mfma_f32_16x16x32_bf16 v[136:139], a[168:171], v[88:91], v[136:139]
    s_waitcnt lgkmcnt(5)
    ds_read_b64_tr_b16 a[188:189], v19 offset:8192
    ds_read_b64_tr_b16 a[190:191], v19 offset:12288
    v_exp_f32 v75, v75
    v_mfma_f32_16x16x32_bf16 v[140:143], a[172:175], v[88:91], v[140:143]
    s_waitcnt lgkmcnt(6)
    v_cvt_pk_bf16_f32 v93, v74, v75
    v_mfma_f32_16x16x32_bf16 v[144:147], a[176:179], v[88:91], v[144:147]
    s_waitcnt lgkmcnt(4)
    v_exp_f32 v76, v76
    v_mfma_f32_16x16x32_bf16 v[148:151], a[180:183], v[88:91], v[148:151]
    s_waitcnt lgkmcnt(2)
    v_exp_f32 v77, v77
    v_mfma_f32_16x16x32_bf16 v[152:155], a[184:187], v[88:91], v[152:155]
    s_waitcnt lgkmcnt(0)
    v_exp_f32 v78, v78
    v_cvt_pk_bf16_f32 v94, v76, v77
    v_mfma_f32_16x16x32_bf16 v[156:159], a[188:191], v[88:91], v[156:159]
    v_exp_f32 v79, v79
    s_nop 0
    v_cvt_pk_bf16_f32 v95, v78, v79
    s_nop 1
    v_mfma_f32_16x16x32_bf16 v[160:163], a[160:163], v[92:95], v[160:163]
    v_mfma_f32_16x16x32_bf16 v[164:167], a[164:167], v[92:95], v[164:167]
    v_mfma_f32_16x16x32_bf16 v[168:171], a[168:171], v[92:95], v[168:171]
    v_mfma_f32_16x16x32_bf16 v[172:175], a[172:175], v[92:95], v[172:175]
    v_smfmac_f32_16x16x64_bf16 v[96:99], v[112:115], v[88:95], v116
    v_mfma_f32_16x16x32_bf16 v[176:179], a[176:179], v[92:95], v[176:179]
    v_mfma_f32_16x16x32_bf16 v[180:183], a[180:183], v[92:95], v[180:183]
    v_mfma_f32_16x16x32_bf16 v[184:187], a[184:187], v[92:95], v[184:187]
    v_mfma_f32_16x16x32_bf16 v[188:191], a[188:191], v[92:95], v[188:191]
    s_waitcnt vmcnt(4)
    s_add_u32 m0, s15, 16384
    s_xor_b32 s28, s66, 4096
    buffer_load_dwordx4 v22, s[28:31], 0 offen offset:0 nt lds
    buffer_load_dwordx4 v23, s[28:31], 0 offen offset:1024 nt lds
    s_waitcnt vmcnt(4)
    ds_read_b128 v[192:195], v120 offset:8192
    ds_read_b128 v[196:199], v121 offset:8192
    ds_read_b128 v[200:203], v122 offset:8192
    ds_read_b128 v[204:207], v123 offset:8192
    s_add_u32 m0, s16, 12288
    s_xor_b32 s20, s64, 12288
    buffer_load_dwordx4 v24, s[20:23], 0 offen offset:0 nt lds
    buffer_load_dwordx4 v5, s[20:23], 0 offen offset:1024 nt lds
    s_waitcnt lgkmcnt(3)
    v_lshlrev_b32 v208, 16, v192
    v_and_b32 v209, s18, v192
    v_lshlrev_b32 v210, 16, v193
    v_and_b32 v211, s18, v193
    v_lshlrev_b32 v212, 16, v194
    v_and_b32 v213, s18, v194
    v_lshlrev_b32 v214, 16, v195
    v_and_b32 v215, s18, v195
    v_pk_mul_f32 v[208:209], v[208:209], v[34:35] op_sel_hi:[1,0]
    v_pk_mul_f32 v[210:211], v[210:211], v[34:35] op_sel_hi:[1,0]
    v_pk_mul_f32 v[212:213], v[212:213], v[34:35] op_sel_hi:[1,0]
    v_pk_mul_f32 v[214:215], v[214:215], v[34:35] op_sel_hi:[1,0]
    v_cvt_pk_bf16_f32 v208, v208, v209
    v_cvt_pk_bf16_f32 v209, v210, v211
    v_cvt_pk_bf16_f32 v210, v212, v213
    v_cvt_pk_bf16_f32 v211, v214, v215
    v_accvgpr_write_b32 a32, v208
    v_accvgpr_write_b32 a33, v209
    v_accvgpr_write_b32 a34, v210
    v_accvgpr_write_b32 a35, v211
    s_waitcnt lgkmcnt(0)
    v_lshlrev_b32 v216, 16, v196
    v_and_b32 v217, s18, v196
    v_lshlrev_b32 v218, 16, v197
    v_and_b32 v219, s18, v197
    v_lshlrev_b32 v220, 16, v198
    v_and_b32 v221, s18, v198
    v_lshlrev_b32 v222, 16, v199
    v_and_b32 v223, s18, v199
    v_pk_mul_f32 v[216:217], v[216:217], v[34:35] op_sel_hi:[1,0]
    v_pk_mul_f32 v[218:219], v[218:219], v[34:35] op_sel_hi:[1,0]
    v_pk_mul_f32 v[220:221], v[220:221], v[34:35] op_sel_hi:[1,0]
    v_pk_mul_f32 v[222:223], v[222:223], v[34:35] op_sel_hi:[1,0]
    v_cvt_pk_bf16_f32 v216, v216, v217
    v_cvt_pk_bf16_f32 v217, v218, v219
    v_cvt_pk_bf16_f32 v218, v220, v221
    v_cvt_pk_bf16_f32 v219, v222, v223
    v_accvgpr_write_b32 a36, v216
    v_accvgpr_write_b32 a37, v217
    v_accvgpr_write_b32 a38, v218
    v_accvgpr_write_b32 a39, v219
    v_lshlrev_b32 v208, 16, v200
    v_and_b32 v209, s18, v200
    v_lshlrev_b32 v210, 16, v201
    v_and_b32 v211, s18, v201
    v_lshlrev_b32 v212, 16, v202
    v_and_b32 v213, s18, v202
    v_lshlrev_b32 v214, 16, v203
    v_and_b32 v215, s18, v203
    v_pk_mul_f32 v[208:209], v[208:209], v[34:35] op_sel_hi:[1,0]
    v_pk_mul_f32 v[210:211], v[210:211], v[34:35] op_sel_hi:[1,0]
    v_pk_mul_f32 v[212:213], v[212:213], v[34:35] op_sel_hi:[1,0]
    v_pk_mul_f32 v[214:215], v[214:215], v[34:35] op_sel_hi:[1,0]
    v_cvt_pk_bf16_f32 v208, v208, v209
    v_cvt_pk_bf16_f32 v209, v210, v211
    v_cvt_pk_bf16_f32 v210, v212, v213
    v_cvt_pk_bf16_f32 v211, v214, v215
    v_accvgpr_write_b32 a40, v208
    v_accvgpr_write_b32 a41, v209
    v_accvgpr_write_b32 a42, v210
    v_accvgpr_write_b32 a43, v211
    v_lshlrev_b32 v216, 16, v204
    v_and_b32 v217, s18, v204
    v_lshlrev_b32 v218, 16, v205
    v_and_b32 v219, s18, v205
    v_lshlrev_b32 v220, 16, v206
    v_and_b32 v221, s18, v206
    v_lshlrev_b32 v222, 16, v207
    v_and_b32 v223, s18, v207
    v_pk_mul_f32 v[216:217], v[216:217], v[34:35] op_sel_hi:[1,0]
    v_pk_mul_f32 v[218:219], v[218:219], v[34:35] op_sel_hi:[1,0]
    v_pk_mul_f32 v[220:221], v[220:221], v[34:35] op_sel_hi:[1,0]
    v_pk_mul_f32 v[222:223], v[222:223], v[34:35] op_sel_hi:[1,0]
    v_cvt_pk_bf16_f32 v216, v216, v217
    v_cvt_pk_bf16_f32 v217, v218, v219
    v_cvt_pk_bf16_f32 v218, v220, v221
    v_cvt_pk_bf16_f32 v219, v222, v223
    v_accvgpr_write_b32 a44, v216
    v_accvgpr_write_b32 a45, v217
    v_accvgpr_write_b32 a46, v218
    v_accvgpr_write_b32 a47, v219
    v_mfma_f32_16x16x32_bf16 v[64:67], a[64:67], a[32:35], 0
    v_mfma_f32_16x16x32_bf16 v[64:67], a[68:71], a[36:39], v[64:67]
    v_mfma_f32_16x16x32_bf16 v[64:67], a[72:75], a[40:43], v[64:67]
    v_mfma_f32_16x16x32_bf16 v[64:67], a[76:79], a[44:47], v[64:67]
    v_mfma_f32_16x16x32_bf16 v[68:71], a[80:83], a[32:35], 0
    v_mfma_f32_16x16x32_bf16 v[68:71], a[84:87], a[36:39], v[68:71]
    v_mfma_f32_16x16x32_bf16 v[68:71], a[88:91], a[40:43], v[68:71]
    v_mfma_f32_16x16x32_bf16 v[68:71], a[92:95], a[44:47], v[68:71]
    s_nop 3
    v_max3_f32 v30, v64, v65, v66
    s_nop 2
    v_max3_f32 v30, v30, v67, v68
    v_max3_f32 v30, v30, v69, v70
    v_max_f32 v30, v30, v71
    v_mov_b32 v31, v30
    s_nop 1
    v_permlane16_swap_b32 v30, v31
    v_max_f32 v30, v30, v31
    v_mov_b32 v31, v30
    s_nop 1
    v_permlane32_swap_b32 v30, v31
    v_max_f32 v30, v30, v31
    v_sub_f32 v56, 0, v30
    v_sub_f32 v57, 0, v30
    v_sub_f32 v58, 0, v30
    v_sub_f32 v59, 0, v30
    v_add_f32 v64, v56, v64
    v_exp_f32 v64, v64
    v_add_f32 v65, v56, v65
    v_exp_f32 v65, v65
    v_add_f32 v66, v56, v66
    v_mfma_f32_16x16x32_bf16 v[72:75], a[96:99], a[32:35], v[56:59]
    v_exp_f32 v66, v66
    v_add_f32 v67, v56, v67
    v_cvt_pk_bf16_f32 v80, v64, v65
    v_mfma_f32_16x16x32_bf16 v[72:75], a[100:103], a[36:39], v[72:75]
    s_waitcnt vmcnt(4)
    v_exp_f32 v67, v67
    v_add_f32 v68, v56, v68
    v_mfma_f32_16x16x32_bf16 v[72:75], a[104:107], a[40:43], v[72:75]
    s_barrier
    v_exp_f32 v68, v68
    v_add_f32 v69, v56, v69
    v_cvt_pk_bf16_f32 v81, v66, v67
    v_mfma_f32_16x16x32_bf16 v[72:75], a[108:111], a[44:47], v[72:75]
    v_exp_f32 v69, v69
    v_add_f32 v70, v56, v70
    v_mfma_f32_16x16x32_bf16 v[76:79], a[112:115], a[32:35], v[56:59]
    ds_read_b128 a[192:195], v8 offset:16384
    v_exp_f32 v70, v70
    v_add_f32 v71, v56, v71
    v_cvt_pk_bf16_f32 v82, v68, v69
    v_mfma_f32_16x16x32_bf16 v[76:79], a[116:119], a[36:39], v[76:79]
    ds_read_b128 a[196:199], v9 offset:16384
    v_exp_f32 v71, v71
    v_mfma_f32_16x16x32_bf16 v[76:79], a[120:123], a[40:43], v[76:79]
    buffer_load_dwordx4 v6, s[20:23], 0 offen offset:2048 nt lds
    v_cvt_pk_bf16_f32 v83, v70, v71
    v_mfma_f32_16x16x32_bf16 v[76:79], a[124:127], a[44:47], v[76:79]
    ds_read_b128 a[200:203], v10 offset:16384
    v_exp_f32 v72, v72
    v_mfma_f32_16x16x32_bf16 v[192:195], a[128:131], v[80:83], 0
    ds_read_b128 a[204:207], v11 offset:16384
    ds_read_b128 a[208:211], v8 offset:20480
    v_mfma_f32_16x16x32_bf16 v[196:199], a[132:135], v[80:83], 0
    v_exp_f32 v73, v73
    v_mfma_f32_16x16x32_bf16 v[200:203], a[136:139], v[80:83], 0
    ds_read_b128 a[212:215], v9 offset:20480
    v_cvt_pk_bf16_f32 v84, v72, v73
    v_mfma_f32_16x16x32_bf16 v[204:207], a[140:143], v[80:83], 0
    buffer_load_dwordx4 v7, s[20:23], 0 offen offset:3072 nt lds
    v_exp_f32 v74, v74
    v_mfma_f32_16x16x32_bf16 v[208:211], a[144:147], v[80:83], 0
    ds_read_b128 a[216:219], v10 offset:20480
    ds_read_b128 a[220:223], v11 offset:20480
    v_mfma_f32_16x16x32_bf16 v[212:215], a[148:151], v[80:83], 0
    v_exp_f32 v75, v75
    v_mfma_f32_16x16x32_bf16 v[216:219], a[152:155], v[80:83], 0
    v_cvt_pk_bf16_f32 v85, v74, v75
    v_mfma_f32_16x16x32_bf16 v[220:223], a[156:159], v[80:83], 0
    s_waitcnt lgkmcnt(6)
    v_exp_f32 v76, v76
    v_mfma_f32_16x16x32_bf16 v[64:67], a[192:195], a[0:3], v[48:51]
    v_mfma_f32_16x16x32_bf16 v[64:67], a[196:199], a[4:7], v[64:67]
    s_waitcnt lgkmcnt(4)
    v_exp_f32 v77, v77
    v_mfma_f32_16x16x32_bf16 v[64:67], a[200:203], a[8:11], v[64:67]
    v_cvt_pk_bf16_f32 v86, v76, v77
    v_mfma_f32_16x16x32_bf16 v[64:67], a[204:207], a[12:15], v[64:67]
    s_waitcnt lgkmcnt(2)
    v_exp_f32 v78, v78
    v_mfma_f32_16x16x32_bf16 v[68:71], a[208:211], a[0:3], v[48:51]
    v_mfma_f32_16x16x32_bf16 v[68:71], a[212:215], a[4:7], v[68:71]
    s_waitcnt lgkmcnt(1)
    v_exp_f32 v79, v79
    v_mfma_f32_16x16x32_bf16 v[68:71], a[216:219], a[8:11], v[68:71]
    s_waitcnt lgkmcnt(0)
    v_cvt_pk_bf16_f32 v87, v78, v79
    v_mfma_f32_16x16x32_bf16 v[68:71], a[220:223], a[12:15], v[68:71]
    s_waitcnt vmcnt(4)
    v_exp_f32 v64, v64
    v_mfma_f32_16x16x32_bf16 v[192:195], a[160:163], v[84:87], v[192:195]
    s_barrier
    ds_read_b64_tr_b16 a[224:225], v12 offset:16384
    v_mfma_f32_16x16x32_bf16 v[196:199], a[164:167], v[84:87], v[196:199]
    v_exp_f32 v65, v65
    v_mfma_f32_16x16x32_bf16 v[200:203], a[168:171], v[84:87], v[200:203]
    ds_read_b64_tr_b16 a[226:227], v12 offset:20480
    v_cvt_pk_bf16_f32 v88, v64, v65
    v_mfma_f32_16x16x32_bf16 v[204:207], a[172:175], v[84:87], v[204:207]
L_hop0:
    s_cbranch_execz L_hop4
    v_exp_f32 v66, v66
    v_smfmac_f32_16x16x64_bf16 v[100:103], v[104:107], v[80:87], v116
    ds_read_b64_tr_b16 a[228:229], v13 offset:16384
    ds_read_b64_tr_b16 a[230:231], v13 offset:20480
    v_mfma_f32_16x16x32_bf16 v[208:211], a[176:179], v[84:87], v[208:211]
    ds_read_b64_tr_b16 a[232:233], v14 offset:16384
    ds_read_b64_tr_b16 a[234:235], v14 offset:20480
    v_mfma_f32_16x16x32_bf16 v[212:215], a[180:183], v[84:87], v[212:215]
    ds_read_b64_tr_b16 a[236:237], v15 offset:16384
    v_exp_f32 v67, v67
    v_mfma_f32_16x16x32_bf16 v[216:219], a[184:187], v[84:87], v[216:219]
    ds_read_b64_tr_b16 a[238:239], v15 offset:20480
    v_cvt_pk_bf16_f32 v89, v66, v67
    v_mfma_f32_16x16x32_bf16 v[220:223], a[188:191], v[84:87], v[220:223]
    s_add_u32 m0, s14, 24576
    v_exp_f32 v68, v68
    v_mfma_f32_16x16x32_bf16 v[72:75], a[192:195], a[16:19], v[52:55]
    s_xor_b32 s24, s65, 6144
    buffer_load_dwordx4 v20, s[24:27], 0 offen offset:0 nt lds
    ds_read_b64_tr_b16 a[240:241], v16 offset:16384
    v_mfma_f32_16x16x32_bf16 v[72:75], a[196:199], a[20:23], v[72:75]
    v_exp_f32 v69, v69
    v_mfma_f32_16x16x32_bf16 v[72:75], a[200:203], a[24:27], v[72:75]
    ds_read_b64_tr_b16 a[242:243], v16 offset:20480
    v_cvt_pk_bf16_f32 v90, v68, v69
    v_mfma_f32_16x16x32_bf16 v[72:75], a[204:207], a[28:31], v[72:75]
    v_exp_f32 v70, v70
    v_mfma_f32_16x16x32_bf16 v[76:79], a[208:211], a[16:19], v[52:55]
    ds_read_b64_tr_b16 a[244:245], v17 offset:16384
    ds_read_b64_tr_b16 a[246:247], v17 offset:20480
    v_mfma_f32_16x16x32_bf16 v[76:79], a[212:215], a[20:23], v[76:79]
    ds_read_b64_tr_b16 a[248:249], v18 offset:16384
    v_exp_f32 v71, v71
    v_mfma_f32_16x16x32_bf16 v[76:79], a[216:219], a[24:27], v[76:79]
    ds_read_b64_tr_b16 a[250:251], v18 offset:20480
    v_cvt_pk_bf16_f32 v91, v70, v71
    v_mfma_f32_16x16x32_bf16 v[76:79], a[220:223], a[28:31], v[76:79]
    s_waitcnt lgkmcnt(6)
    v_exp_f32 v72, v72
    v_mfma_f32_16x16x32_bf16 v[128:131], a[224:227], v[88:91], v[128:131]
    ds_read_b64_tr_b16 a[252:253], v19 offset:16384
    ds_read_b64_tr_b16 a[254:255], v19 offset:20480
    v_mfma_f32_16x16x32_bf16 v[132:135], a[228:231], v[88:91], v[132:135]
    v_exp_f32 v73, v73
    v_mfma_f32_16x16x32_bf16 v[136:139], a[232:235], v[88:91], v[136:139]
    v_cvt_pk_bf16_f32 v92, v72, v73
    v_mfma_f32_16x16x32_bf16 v[140:143], a[236:239], v[88:91], v[140:143]
    s_waitcnt lgkmcnt(6)
    v_exp_f32 v74, v74
    v_mfma_f32_16x16x32_bf16 v[144:147], a[240:243], v[88:91], v[144:147]
    s_waitcnt lgkmcnt(4)
    v_mfma_f32_16x16x32_bf16 v[148:151], a[244:247], v[88:91], v[148:151]
    s_waitcnt lgkmcnt(2)
    v_exp_f32 v75, v75
    v_mfma_f32_16x16x32_bf16 v[152:155], a[248:251], v[88:91], v[152:155]
    s_waitcnt lgkmcnt(0)
    v_cvt_pk_bf16_f32 v93, v74, v75
    v_mfma_f32_16x16x32_bf16 v[156:159], a[252:255], v[88:91], v[156:159]
    v_exp_f32 v76, v76
    v_mfma_f32_16x16x32_bf16 v[64:67], a[192:195], a[32:35], v[56:59]
    v_mfma_f32_16x16x32_bf16 v[64:67], a[196:199], a[36:39], v[64:67]
    v_exp_f32 v77, v77
    v_mfma_f32_16x16x32_bf16 v[64:67], a[200:203], a[40:43], v[64:67]
    v_cvt_pk_bf16_f32 v94, v76, v77
    v_mfma_f32_16x16x32_bf16 v[64:67], a[204:207], a[44:47], v[64:67]
    v_exp_f32 v78, v78
    v_mfma_f32_16x16x32_bf16 v[68:71], a[208:211], a[32:35], v[56:59]
    v_mfma_f32_16x16x32_bf16 v[68:71], a[212:215], a[36:39], v[68:71]
    v_exp_f32 v79, v79
    v_mfma_f32_16x16x32_bf16 v[68:71], a[216:219], a[40:43], v[68:71]
    v_cvt_pk_bf16_f32 v95, v78, v79
    v_mfma_f32_16x16x32_bf16 v[68:71], a[220:223], a[44:47], v[68:71]
    s_nop 0
    v_exp_f32 v64, v64
    v_mfma_f32_16x16x32_bf16 v[160:163], a[224:227], v[92:95], v[160:163]
    v_exp_f32 v65, v65
    v_mfma_f32_16x16x32_bf16 v[164:167], a[228:231], v[92:95], v[164:167]
    v_exp_f32 v66, v66
    v_cvt_pk_bf16_f32 v80, v64, v65
    v_mfma_f32_16x16x32_bf16 v[168:171], a[232:235], v[92:95], v[168:171]
    v_exp_f32 v67, v67
    v_mfma_f32_16x16x32_bf16 v[172:175], a[236:239], v[92:95], v[172:175]
    v_cvt_pk_bf16_f32 v81, v66, v67
    v_smfmac_f32_16x16x64_bf16 v[96:99], v[112:115], v[88:95], v116
    v_mfma_f32_16x16x32_bf16 v[176:179], a[240:243], v[92:95], v[176:179]
    v_exp_f32 v68, v68
    v_mfma_f32_16x16x32_bf16 v[180:183], a[244:247], v[92:95], v[180:183]
    v_exp_f32 v69, v69
    v_mfma_f32_16x16x32_bf16 v[184:187], a[248:251], v[92:95], v[184:187]
    v_exp_f32 v70, v70
    v_cvt_pk_bf16_f32 v82, v68, v69
    v_mfma_f32_16x16x32_bf16 v[188:191], a[252:255], v[92:95], v[188:191]
    v_exp_f32 v71, v71
    s_nop 0
    v_cvt_pk_bf16_f32 v83, v70, v71
    s_nop 1
    v_mfma_f32_16x16x32_bf16 v[192:195], a[224:227], v[80:83], v[192:195]
    v_mfma_f32_16x16x32_bf16 v[196:199], a[228:231], v[80:83], v[196:199]
    v_mfma_f32_16x16x32_bf16 v[200:203], a[232:235], v[80:83], v[200:203]
    v_mfma_f32_16x16x32_bf16 v[204:207], a[236:239], v[80:83], v[204:207]
    v_mfma_f32_16x16x32_bf16 v[208:211], a[240:243], v[80:83], v[208:211]
    v_mfma_f32_16x16x32_bf16 v[212:215], a[244:247], v[80:83], v[212:215]
    v_mfma_f32_16x16x32_bf16 v[216:219], a[248:251], v[80:83], v[216:219]
    v_mfma_f32_16x16x32_bf16 v[220:223], a[252:255], v[80:83], v[220:223]
    s_waitcnt vmcnt(3)
    buffer_load_dwordx4 v21, s[24:27], 0 offen offset:1024 nt lds
    s_waitcnt vmcnt(2)
    ds_read_b128 v[224:227], v120 offset:12288
    ds_read_b128 v[228:231], v121 offset:12288
    ds_read_b128 v[232:235], v122 offset:12288
    ds_read_b128 v[236:239], v123 offset:12288
    s_add_u32 m0, s15, 24576
    s_xor_b32 s28, s66, 6144
    buffer_load_dwordx4 v22, s[28:31], 0 offen offset:0 nt lds
    buffer_load_dwordx4 v23, s[28:31], 0 offen offset:1024 nt lds
    s_waitcnt lgkmcnt(3)
    v_lshlrev_b32 v240, 16, v224
    v_and_b32 v241, s18, v224
    v_lshlrev_b32 v242, 16, v225
    v_and_b32 v243, s18, v225
    v_lshlrev_b32 v244, 16, v226
    v_and_b32 v245, s18, v226
    v_lshlrev_b32 v246, 16, v227
    v_and_b32 v247, s18, v227
    v_pk_mul_f32 v[240:241], v[240:241], v[34:35] op_sel_hi:[1,0]
    v_pk_mul_f32 v[242:243], v[242:243], v[34:35] op_sel_hi:[1,0]
    v_pk_mul_f32 v[244:245], v[244:245], v[34:35] op_sel_hi:[1,0]
    v_pk_mul_f32 v[246:247], v[246:247], v[34:35] op_sel_hi:[1,0]
    v_cvt_pk_bf16_f32 v240, v240, v241
    v_cvt_pk_bf16_f32 v241, v242, v243
    v_cvt_pk_bf16_f32 v242, v244, v245
    v_cvt_pk_bf16_f32 v243, v246, v247
    v_accvgpr_write_b32 a48, v240
    v_accvgpr_write_b32 a49, v241
    v_accvgpr_write_b32 a50, v242
    v_accvgpr_write_b32 a51, v243
    s_waitcnt lgkmcnt(0)
    v_lshlrev_b32 v248, 16, v228
    v_and_b32 v249, s18, v228
    v_lshlrev_b32 v250, 16, v229
    v_and_b32 v251, s18, v229
    v_lshlrev_b32 v252, 16, v230
    v_and_b32 v253, s18, v230
    v_lshlrev_b32 v254, 16, v231
    v_and_b32 v255, s18, v231
    v_pk_mul_f32 v[248:249], v[248:249], v[34:35] op_sel_hi:[1,0]
    v_pk_mul_f32 v[250:251], v[250:251], v[34:35] op_sel_hi:[1,0]
    v_pk_mul_f32 v[252:253], v[252:253], v[34:35] op_sel_hi:[1,0]
    v_pk_mul_f32 v[254:255], v[254:255], v[34:35] op_sel_hi:[1,0]
    v_cvt_pk_bf16_f32 v248, v248, v249
    v_cvt_pk_bf16_f32 v249, v250, v251
    v_cvt_pk_bf16_f32 v250, v252, v253
    v_cvt_pk_bf16_f32 v251, v254, v255
    v_accvgpr_write_b32 a52, v248
    v_accvgpr_write_b32 a53, v249
    v_accvgpr_write_b32 a54, v250
    v_accvgpr_write_b32 a55, v251
    v_lshlrev_b32 v240, 16, v232
    v_and_b32 v241, s18, v232
    v_lshlrev_b32 v242, 16, v233
    v_and_b32 v243, s18, v233
    v_lshlrev_b32 v244, 16, v234
    v_and_b32 v245, s18, v234
    v_lshlrev_b32 v246, 16, v235
    v_and_b32 v247, s18, v235
    v_pk_mul_f32 v[240:241], v[240:241], v[34:35] op_sel_hi:[1,0]
    v_pk_mul_f32 v[242:243], v[242:243], v[34:35] op_sel_hi:[1,0]
    v_pk_mul_f32 v[244:245], v[244:245], v[34:35] op_sel_hi:[1,0]
    v_pk_mul_f32 v[246:247], v[246:247], v[34:35] op_sel_hi:[1,0]
    v_cvt_pk_bf16_f32 v240, v240, v241
    v_cvt_pk_bf16_f32 v241, v242, v243
    v_cvt_pk_bf16_f32 v242, v244, v245
    v_cvt_pk_bf16_f32 v243, v246, v247
    v_accvgpr_write_b32 a56, v240
    v_accvgpr_write_b32 a57, v241
    v_accvgpr_write_b32 a58, v242
    v_accvgpr_write_b32 a59, v243
    v_lshlrev_b32 v248, 16, v236
    v_and_b32 v249, s18, v236
    v_lshlrev_b32 v250, 16, v237
    v_and_b32 v251, s18, v237
    v_lshlrev_b32 v252, 16, v238
    v_and_b32 v253, s18, v238
    v_lshlrev_b32 v254, 16, v239
    v_and_b32 v255, s18, v239
    v_pk_mul_f32 v[248:249], v[248:249], v[34:35] op_sel_hi:[1,0]
    v_pk_mul_f32 v[250:251], v[250:251], v[34:35] op_sel_hi:[1,0]
    v_pk_mul_f32 v[252:253], v[252:253], v[34:35] op_sel_hi:[1,0]
    v_pk_mul_f32 v[254:255], v[254:255], v[34:35] op_sel_hi:[1,0]
    v_cvt_pk_bf16_f32 v248, v248, v249
    v_cvt_pk_bf16_f32 v249, v250, v251
    v_cvt_pk_bf16_f32 v250, v252, v253
    v_cvt_pk_bf16_f32 v251, v254, v255
    v_accvgpr_write_b32 a60, v248
    v_accvgpr_write_b32 a61, v249
    v_accvgpr_write_b32 a62, v250
    v_accvgpr_write_b32 a63, v251
    v_mfma_f32_16x16x32_bf16 v[72:75], a[96:99], a[48:51], 0
    v_mfma_f32_16x16x32_bf16 v[72:75], a[100:103], a[52:55], v[72:75]
    v_mfma_f32_16x16x32_bf16 v[72:75], a[104:107], a[56:59], v[72:75]
    v_mfma_f32_16x16x32_bf16 v[72:75], a[108:111], a[60:63], v[72:75]
    v_mfma_f32_16x16x32_bf16 v[76:79], a[112:115], a[48:51], 0
    v_mfma_f32_16x16x32_bf16 v[76:79], a[116:119], a[52:55], v[76:79]
    v_mfma_f32_16x16x32_bf16 v[76:79], a[120:123], a[56:59], v[76:79]
    v_mfma_f32_16x16x32_bf16 v[76:79], a[124:127], a[60:63], v[76:79]
    s_nop 3
    v_max3_f32 v30, v72, v73, v74
    s_nop 2
    v_max3_f32 v30, v30, v75, v76
    v_max3_f32 v30, v30, v77, v78
    v_max_f32 v30, v30, v79
    v_mov_b32 v31, v30
    s_nop 1
    v_permlane16_swap_b32 v30, v31
    v_max_f32 v30, v30, v31
    v_mov_b32 v31, v30
    s_nop 1
    v_permlane32_swap_b32 v30, v31
    v_max_f32 v30, v30, v31
    v_sub_f32 v60, 0, v30
    v_sub_f32 v61, 0, v30
    v_sub_f32 v62, 0, v30
    v_sub_f32 v63, 0, v30
    v_add_f32 v72, v60, v72
    v_exp_f32 v72, v72
    v_add_f32 v73, v60, v73
    v_exp_f32 v73, v73
    v_add_f32 v74, v60, v74
    v_mfma_f32_16x16x32_bf16 v[64:67], a[64:67], a[48:51], v[60:63]
    v_exp_f32 v74, v74
    v_add_f32 v75, v60, v75
    v_cvt_pk_bf16_f32 v84, v72, v73
    v_mfma_f32_16x16x32_bf16 v[64:67], a[68:71], a[52:55], v[64:67]
    v_exp_f32 v75, v75
    v_add_f32 v76, v60, v76
    v_mfma_f32_16x16x32_bf16 v[64:67], a[72:75], a[56:59], v[64:67]
    v_exp_f32 v76, v76
    v_add_f32 v77, v60, v77
    v_cvt_pk_bf16_f32 v85, v74, v75
    v_mfma_f32_16x16x32_bf16 v[64:67], a[76:79], a[60:63], v[64:67]
    v_exp_f32 v77, v77
    v_add_f32 v78, v60, v78
    v_mfma_f32_16x16x32_bf16 v[68:71], a[80:83], a[48:51], v[60:63]
    v_exp_f32 v78, v78
    v_add_f32 v79, v60, v79
    v_cvt_pk_bf16_f32 v86, v76, v77
    v_mfma_f32_16x16x32_bf16 v[68:71], a[84:87], a[52:55], v[68:71]
    s_add_u32 m0, s14, 32768
    v_exp_f32 v79, v79
    v_mfma_f32_16x16x32_bf16 v[68:71], a[88:91], a[56:59], v[68:71]
    s_xor_b32 s24, s65, 8192
    buffer_load_dwordx4 v20, s[24:27], 0 offen offset:0 nt lds
    v_cvt_pk_bf16_f32 v87, v78, v79
    v_mfma_f32_16x16x32_bf16 v[68:71], a[92:95], a[60:63], v[68:71]
    v_exp_f32 v64, v64
    v_mfma_f32_16x16x32_bf16 v[224:227], a[160:163], v[84:87], 0
    v_mfma_f32_16x16x32_bf16 v[228:231], a[164:167], v[84:87], 0
    v_exp_f32 v65, v65
    v_mfma_f32_16x16x32_bf16 v[232:235], a[168:171], v[84:87], 0
    v_cvt_pk_bf16_f32 v88, v64, v65
    v_mfma_f32_16x16x32_bf16 v[236:239], a[172:175], v[84:87], 0
    v_exp_f32 v66, v66
    v_smfmac_f32_16x16x64_bf16 v[100:103], v[112:115], v[80:87], v116
    s_waitcnt vmcnt(3)
    v_mfma_f32_16x16x32_bf16 v[240:243], a[176:179], v[84:87], 0
    s_barrier
    v_mfma_f32_16x16x32_bf16 v[244:247], a[180:183], v[84:87], 0
    v_exp_f32 v67, v67
    v_mfma_f32_16x16x32_bf16 v[248:251], a[184:187], v[84:87], 0
    buffer_load_dwordx4 v21, s[24:27], 0 offen offset:1024 nt lds
    v_cvt_pk_bf16_f32 v89, v66, v67
    v_mfma_f32_16x16x32_bf16 v[252:255], a[188:191], v[84:87], 0
    v_exp_f32 v68, v68
    v_mfma_f32_16x16x32_bf16 v[72:75], a[192:195], a[48:51], v[60:63]
    ds_read_b128 a[96:99], v8 offset:24576
    ds_read_b128 a[100:103], v9 offset:24576
    v_mfma_f32_16x16x32_bf16 v[72:75], a[196:199], a[52:55], v[72:75]
    v_exp_f32 v69, v69
    v_mfma_f32_16x16x32_bf16 v[72:75], a[200:203], a[56:59], v[72:75]
    ds_read_b128 a[104:107], v10 offset:24576
    v_cvt_pk_bf16_f32 v90, v68, v69
    v_mfma_f32_16x16x32_bf16 v[72:75], a[204:207], a[60:63], v[72:75]
    v_exp_f32 v70, v70
    v_mfma_f32_16x16x32_bf16 v[76:79], a[208:211], a[48:51], v[60:63]
    ds_read_b128 a[108:111], v11 offset:24576
    v_mfma_f32_16x16x32_bf16 v[76:79], a[212:215], a[52:55], v[76:79]
    v_exp_f32 v71, v71
    v_mfma_f32_16x16x32_bf16 v[76:79], a[216:219], a[56:59], v[76:79]
    ds_read_b128 a[112:115], v8 offset:28672
    v_cvt_pk_bf16_f32 v91, v70, v71
    v_mfma_f32_16x16x32_bf16 v[76:79], a[220:223], a[60:63], v[76:79]
    v_exp_f32 v72, v72
    v_mfma_f32_16x16x32_bf16 v[224:227], a[128:131], v[88:91], v[224:227]
    ds_read_b128 a[116:119], v9 offset:28672
    ds_read_b128 a[120:123], v10 offset:28672
    v_mfma_f32_16x16x32_bf16 v[228:231], a[132:135], v[88:91], v[228:231]
    v_exp_f32 v73, v73
    v_mfma_f32_16x16x32_bf16 v[232:235], a[136:139], v[88:91], v[232:235]
    ds_read_b128 a[124:127], v11 offset:28672
    v_cvt_pk_bf16_f32 v92, v72, v73
    v_mfma_f32_16x16x32_bf16 v[236:239], a[140:143], v[88:91], v[236:239]
    s_waitcnt vmcnt(2)
    v_exp_f32 v74, v74
    v_mfma_f32_16x16x32_bf16 v[240:243], a[144:147], v[88:91], v[240:243]
    s_barrier
    v_mfma_f32_16x16x32_bf16 v[244:247], a[148:151], v[88:91], v[244:247]
    s_add_u32 m0, s15, 32768
    v_exp_f32 v75, v75
    v_mfma_f32_16x16x32_bf16 v[248:251], a[152:155], v[88:91], v[248:251]
    s_xor_b32 s28, s66, 8192
    buffer_load_dwordx4 v22, s[28:31], 0 offen offset:0 nt lds
    v_cvt_pk_bf16_f32 v93, v74, v75
    v_mfma_f32_16x16x32_bf16 v[252:255], a[156:159], v[88:91], v[252:255]
    s_waitcnt lgkmcnt(3)
    v_exp_f32 v76, v76
    v_mfma_f32_16x16x32_bf16 v[64:67], a[96:99], a[0:3], v[48:51]
    ds_read_b64_tr_b16 a[160:161], v12 offset:24576
    ds_read_b64_tr_b16 a[162:163], v12 offset:28672
    v_mfma_f32_16x16x32_bf16 v[64:67], a[100:103], a[4:7], v[64:67]
    v_exp_f32 v77, v77
    v_mfma_f32_16x16x32_bf16 v[64:67], a[104:107], a[8:11], v[64:67]
    ds_read_b64_tr_b16 a[164:165], v13 offset:24576
    v_cvt_pk_bf16_f32 v94, v76, v77
    v_mfma_f32_16x16x32_bf16 v[64:67], a[108:111], a[12:15], v[64:67]
    v_exp_f32 v78, v78
    v_mfma_f32_16x16x32_bf16 v[68:71], a[112:115], a[0:3], v[48:51]
    s_waitcnt lgkmcnt(3)
    ds_read_b64_tr_b16 a[166:167], v13 offset:28672
    v_mfma_f32_16x16x32_bf16 v[68:71], a[116:119], a[4:7], v[68:71]
    v_exp_f32 v79, v79
    v_mfma_f32_16x16x32_bf16 v[68:71], a[120:123], a[8:11], v[68:71]
    ds_read_b64_tr_b16 a[168:169], v14 offset:24576
    v_cvt_pk_bf16_f32 v95, v78, v79
    v_mfma_f32_16x16x32_bf16 v[68:71], a[124:127], a[12:15], v[68:71]
    v_exp_f32 v64, v64
    v_mfma_f32_16x16x32_bf16 v[224:227], a[224:227], v[92:95], v[224:227]
    ds_read_b64_tr_b16 a[170:171], v14 offset:28672
    ds_read_b64_tr_b16 a[172:173], v15 offset:24576
    v_mfma_f32_16x16x32_bf16 v[228:231], a[228:231], v[92:95], v[228:231]
    v_exp_f32 v65, v65
    v_mfma_f32_16x16x32_bf16 v[232:235], a[232:235], v[92:95], v[232:235]
    ds_read_b64_tr_b16 a[174:175], v15 offset:28672
    v_cvt_pk_bf16_f32 v80, v64, v65
    v_mfma_f32_16x16x32_bf16 v[236:239], a[236:239], v[92:95], v[236:239]
    v_exp_f32 v66, v66
    v_smfmac_f32_16x16x64_bf16 v[100:103], v[108:111], v[88:95], v116
    ds_read_b64_tr_b16 a[176:177], v16 offset:24576
    v_mfma_f32_16x16x32_bf16 v[240:243], a[240:243], v[92:95], v[240:243]
    ds_read_b64_tr_b16 a[178:179], v16 offset:28672
    ds_read_b64_tr_b16 a[180:181], v17 offset:24576
    v_mfma_f32_16x16x32_bf16 v[244:247], a[244:247], v[92:95], v[244:247]
    v_exp_f32 v67, v67
    v_mfma_f32_16x16x32_bf16 v[248:251], a[248:251], v[92:95], v[248:251]
    buffer_load_dwordx4 v23, s[28:31], 0 offen offset:1024 nt lds
    v_cvt_pk_bf16_f32 v81, v66, v67
    v_mfma_f32_16x16x32_bf16 v[252:255], a[252:255], v[92:95], v[252:255]
    v_exp_f32 v68, v68
    v_mfma_f32_16x16x32_bf16 v[72:75], a[96:99], a[16:19], v[52:55]
    ds_read_b64_tr_b16 a[182:183], v17 offset:28672
    v_mfma_f32_16x16x32_bf16 v[72:75], a[100:103], a[20:23], v[72:75]
    v_exp_f32 v69, v69
    v_mfma_f32_16x16x32_bf16 v[72:75], a[104:107], a[24:27], v[72:75]
    ds_read_b64_tr_b16 a[184:185], v18 offset:24576
    v_cvt_pk_bf16_f32 v82, v68, v69
    v_mfma_f32_16x16x32_bf16 v[72:75], a[108:111], a[28:31], v[72:75]
    v_exp_f32 v70, v70
    v_mfma_f32_16x16x32_bf16 v[76:79], a[112:115], a[16:19], v[52:55]
    ds_read_b64_tr_b16 a[186:187], v18 offset:28672
    ds_read_b64_tr_b16 a[188:189], v19 offset:24576
    v_mfma_f32_16x16x32_bf16 v[76:79], a[116:119], a[20:23], v[76:79]
    v_exp_f32 v71, v71
    v_mfma_f32_16x16x32_bf16 v[76:79], a[120:123], a[24:27], v[76:79]
    ds_read_b64_tr_b16 a[190:191], v19 offset:28672
    v_cvt_pk_bf16_f32 v83, v70, v71
    v_mfma_f32_16x16x32_bf16 v[76:79], a[124:127], a[28:31], v[76:79]
    s_waitcnt lgkmcnt(5)
    v_exp_f32 v72, v72
    v_mfma_f32_16x16x32_bf16 v[128:131], a[160:163], v[80:83], v[128:131]
    v_mfma_f32_16x16x32_bf16 v[132:135], a[164:167], v[80:83], v[132:135]
    v_exp_f32 v73, v73
    v_mfma_f32_16x16x32_bf16 v[136:139], a[168:171], v[80:83], v[136:139]
    v_cvt_pk_bf16_f32 v84, v72, v73
    v_mfma_f32_16x16x32_bf16 v[140:143], a[172:175], v[80:83], v[140:143]
    v_exp_f32 v74, v74
    v_mfma_f32_16x16x32_bf16 v[144:147], a[176:179], v[80:83], v[144:147]
    s_waitcnt lgkmcnt(4)
    v_mfma_f32_16x16x32_bf16 v[148:151], a[180:183], v[80:83], v[148:151]
    s_waitcnt lgkmcnt(2)
    s_add_u32 m0, s14, 40960
    v_exp_f32 v75, v75
    v_mfma_f32_16x16x32_bf16 v[152:155], a[184:187], v[80:83], v[152:155]
    s_waitcnt lgkmcnt(0)
    s_xor_b32 s24, s65, 10240
    buffer_load_dwordx4 v20, s[24:27], 0 offen offset:0 nt lds
    v_cvt_pk_bf16_f32 v85, v74, v75
    v_mfma_f32_16x16x32_bf16 v[156:159], a[188:191], v[80:83], v[156:159]
    v_exp_f32 v76, v76
    v_mfma_f32_16x16x32_bf16 v[64:67], a[96:99], a[32:35], v[56:59]
    v_mfma_f32_16x16x32_bf16 v[64:67], a[100:103], a[36:39], v[64:67]
    v_exp_f32 v77, v77
    v_mfma_f32_16x16x32_bf16 v[64:67], a[104:107], a[40:43], v[64:67]
    v_cvt_pk_bf16_f32 v86, v76, v77
    v_mfma_f32_16x16x32_bf16 v[64:67], a[108:111], a[44:47], v[64:67]
    v_exp_f32 v78, v78
    v_mfma_f32_16x16x32_bf16 v[68:71], a[112:115], a[32:35], v[56:59]
    v_mfma_f32_16x16x32_bf16 v[68:71], a[116:119], a[36:39], v[68:71]
    v_exp_f32 v79, v79
    v_mfma_f32_16x16x32_bf16 v[68:71], a[120:123], a[40:43], v[68:71]
    v_cvt_pk_bf16_f32 v87, v78, v79
    v_mfma_f32_16x16x32_bf16 v[68:71], a[124:127], a[44:47], v[68:71]
    s_nop 0
    v_exp_f32 v64, v64
    v_mfma_f32_16x16x32_bf16 v[160:163], a[160:163], v[84:87], v[160:163]
    v_mfma_f32_16x16x32_bf16 v[164:167], a[164:167], v[84:87], v[164:167]
    v_exp_f32 v65, v65
    v_mfma_f32_16x16x32_bf16 v[168:171], a[168:171], v[84:87], v[168:171]
    v_cvt_pk_bf16_f32 v88, v64, v65
    v_mfma_f32_16x16x32_bf16 v[172:175], a[172:175], v[84:87], v[172:175]
    v_exp_f32 v66, v66
    v_smfmac_f32_16x16x64_bf16 v[96:99], v[112:115], v[80:87], v116
    s_waitcnt vmcnt(3)
    v_mfma_f32_16x16x32_bf16 v[176:179], a[176:179], v[84:87], v[176:179]
    s_barrier
    buffer_load_dwordx4 v21, s[24:27], 0 offen offset:1024 nt lds
    v_mfma_f32_16x16x32_bf16 v[180:183], a[180:183], v[84:87], v[180:183]
    v_exp_f32 v67, v67
    v_mfma_f32_16x16x32_bf16 v[184:187], a[184:187], v[84:87], v[184:187]
    ds_read_b128 a[64:67], v8 offset:32768
    v_cvt_pk_bf16_f32 v89, v66, v67
    v_mfma_f32_16x16x32_bf16 v[188:191], a[188:191], v[84:87], v[188:191]
    v_exp_f32 v68, v68
    v_mfma_f32_16x16x32_bf16 v[72:75], a[96:99], a[48:51], v[60:63]
    ds_read_b128 a[68:71], v9 offset:32768
    v_mfma_f32_16x16x32_bf16 v[72:75], a[100:103], a[52:55], v[72:75]
    v_exp_f32 v69, v69
    v_mfma_f32_16x16x32_bf16 v[72:75], a[104:107], a[56:59], v[72:75]
    ds_read_b128 a[72:75], v10 offset:32768
    v_cvt_pk_bf16_f32 v90, v68, v69
    v_mfma_f32_16x16x32_bf16 v[72:75], a[108:111], a[60:63], v[72:75]
    v_exp_f32 v70, v70
    v_mfma_f32_16x16x32_bf16 v[76:79], a[112:115], a[48:51], v[60:63]
    ds_read_b128 a[76:79], v11 offset:32768
    ds_read_b128 a[80:83], v8 offset:36864
    v_mfma_f32_16x16x32_bf16 v[76:79], a[116:119], a[52:55], v[76:79]
    v_exp_f32 v71, v71
    v_mfma_f32_16x16x32_bf16 v[76:79], a[120:123], a[56:59], v[76:79]
    ds_read_b128 a[84:87], v9 offset:36864
    v_cvt_pk_bf16_f32 v91, v70, v71
    v_mfma_f32_16x16x32_bf16 v[76:79], a[124:127], a[60:63], v[76:79]
    v_exp_f32 v72, v72
    v_mfma_f32_16x16x32_bf16 v[192:195], a[160:163], v[88:91], v[192:195]
    ds_read_b128 a[88:91], v10 offset:36864
    v_mfma_f32_16x16x32_bf16 v[196:199], a[164:167], v[88:91], v[196:199]
    v_exp_f32 v73, v73
    v_mfma_f32_16x16x32_bf16 v[200:203], a[168:171], v[88:91], v[200:203]
    ds_read_b128 a[92:95], v11 offset:36864
    v_cvt_pk_bf16_f32 v92, v72, v73
    v_mfma_f32_16x16x32_bf16 v[204:207], a[172:175], v[88:91], v[204:207]
    s_add_u32 m0, s15, 40960
    s_waitcnt vmcnt(2)
    v_exp_f32 v74, v74
    v_mfma_f32_16x16x32_bf16 v[208:211], a[176:179], v[88:91], v[208:211]
    s_xor_b32 s28, s66, 10240
    s_barrier
    buffer_load_dwordx4 v22, s[28:31], 0 offen offset:0 nt lds
    v_mfma_f32_16x16x32_bf16 v[212:215], a[180:183], v[88:91], v[212:215]
    v_exp_f32 v75, v75
    v_mfma_f32_16x16x32_bf16 v[216:219], a[184:187], v[88:91], v[216:219]
    ds_read_b64_tr_b16 a[128:129], v12 offset:32768
    v_cvt_pk_bf16_f32 v93, v74, v75
    v_mfma_f32_16x16x32_bf16 v[220:223], a[188:191], v[88:91], v[220:223]
    s_waitcnt lgkmcnt(3)
    v_exp_f32 v76, v76
    v_mfma_f32_16x16x32_bf16 v[64:67], a[64:67], a[0:3], v[48:51]
    ds_read_b64_tr_b16 a[130:131], v12 offset:36864
    v_mfma_f32_16x16x32_bf16 v[64:67], a[68:71], a[4:7], v[64:67]
    v_exp_f32 v77, v77
    v_mfma_f32_16x16x32_bf16 v[64:67], a[72:75], a[8:11], v[64:67]
    ds_read_b64_tr_b16 a[132:133], v13 offset:32768
    v_cvt_pk_bf16_f32 v94, v76, v77
    v_mfma_f32_16x16x32_bf16 v[64:67], a[76:79], a[12:15], v[64:67]
    v_exp_f32 v78, v78
    v_mfma_f32_16x16x32_bf16 v[68:71], a[80:83], a[0:3], v[48:51]
    ds_read_b64_tr_b16 a[134:135], v13 offset:36864
    ds_read_b64_tr_b16 a[136:137], v14 offset:32768
    v_mfma_f32_16x16x32_bf16 v[68:71], a[84:87], a[4:7], v[68:71]
    s_waitcnt lgkmcnt(5)
    v_exp_f32 v79, v79
    v_mfma_f32_16x16x32_bf16 v[68:71], a[88:91], a[8:11], v[68:71]
    ds_read_b64_tr_b16 a[138:139], v14 offset:36864
    v_cvt_pk_bf16_f32 v95, v78, v79
    v_mfma_f32_16x16x32_bf16 v[68:71], a[92:95], a[12:15], v[68:71]
    v_exp_f32 v64, v64
    v_mfma_f32_16x16x32_bf16 v[224:227], a[160:163], v[92:95], v[224:227]
    ds_read_b64_tr_b16 a[140:141], v15 offset:32768
    v_mfma_f32_16x16x32_bf16 v[228:231], a[164:167], v[92:95], v[228:231]
    v_exp_f32 v65, v65
    v_mfma_f32_16x16x32_bf16 v[232:235], a[168:171], v[92:95], v[232:235]
    buffer_load_dwordx4 v23, s[28:31], 0 offen offset:1024 nt lds
    v_cvt_pk_bf16_f32 v80, v64, v65
    v_mfma_f32_16x16x32_bf16 v[236:239], a[172:175], v[92:95], v[236:239]
    v_exp_f32 v66, v66
    v_smfmac_f32_16x16x64_bf16 v[100:103], v[112:115], v[88:95], v116
    ds_read_b64_tr_b16 a[142:143], v15 offset:36864
    ds_read_b64_tr_b16 a[144:145], v16 offset:32768
    v_mfma_f32_16x16x32_bf16 v[240:243], a[176:179], v[92:95], v[240:243]
    ds_read_b64_tr_b16 a[146:147], v16 offset:36864
    v_mfma_f32_16x16x32_bf16 v[244:247], a[180:183], v[92:95], v[244:247]
    v_exp_f32 v67, v67
    v_mfma_f32_16x16x32_bf16 v[248:251], a[184:187], v[92:95], v[248:251]
    ds_read_b64_tr_b16 a[148:149], v17 offset:32768
    v_cvt_pk_bf16_f32 v81, v66, v67
    v_mfma_f32_16x16x32_bf16 v[252:255], a[188:191], v[92:95], v[252:255]
    v_exp_f32 v68, v68
    v_mfma_f32_16x16x32_bf16 v[72:75], a[64:67], a[16:19], v[52:55]
    ds_read_b64_tr_b16 a[150:151], v17 offset:36864
    ds_read_b64_tr_b16 a[152:153], v18 offset:32768
    v_mfma_f32_16x16x32_bf16 v[72:75], a[68:71], a[20:23], v[72:75]
    v_exp_f32 v69, v69
    v_mfma_f32_16x16x32_bf16 v[72:75], a[72:75], a[24:27], v[72:75]
    ds_read_b64_tr_b16 a[154:155], v18 offset:36864
    v_cvt_pk_bf16_f32 v82, v68, v69
    v_mfma_f32_16x16x32_bf16 v[72:75], a[76:79], a[28:31], v[72:75]
    v_exp_f32 v70, v70
    v_mfma_f32_16x16x32_bf16 v[76:79], a[80:83], a[16:19], v[52:55]
    ds_read_b64_tr_b16 a[156:157], v19 offset:32768
    v_mfma_f32_16x16x32_bf16 v[76:79], a[84:87], a[20:23], v[76:79]
    v_exp_f32 v71, v71
    v_mfma_f32_16x16x32_bf16 v[76:79], a[88:91], a[24:27], v[76:79]
    ds_read_b64_tr_b16 a[158:159], v19 offset:36864
    v_cvt_pk_bf16_f32 v83, v70, v71
    v_mfma_f32_16x16x32_bf16 v[76:79], a[92:95], a[28:31], v[76:79]
    s_waitcnt lgkmcnt(5)
    s_add_u32 m0, s14, 0
    v_exp_f32 v72, v72
    v_mfma_f32_16x16x32_bf16 v[128:131], a[128:131], v[80:83], v[128:131]
    s_xor_b32 s24, s65, 12288
    buffer_load_dwordx4 v20, s[24:27], 0 offen offset:0 nt lds
    v_mfma_f32_16x16x32_bf16 v[132:135], a[132:135], v[80:83], v[132:135]
    v_exp_f32 v73, v73
    v_mfma_f32_16x16x32_bf16 v[136:139], a[136:139], v[80:83], v[136:139]
    v_cvt_pk_bf16_f32 v84, v72, v73
    v_mfma_f32_16x16x32_bf16 v[140:143], a[140:143], v[80:83], v[140:143]
    v_exp_f32 v74, v74
    v_mfma_f32_16x16x32_bf16 v[144:147], a[144:147], v[80:83], v[144:147]
    s_waitcnt lgkmcnt(2)
    v_mfma_f32_16x16x32_bf16 v[148:151], a[148:151], v[80:83], v[148:151]
    v_exp_f32 v75, v75
    v_mfma_f32_16x16x32_bf16 v[152:155], a[152:155], v[80:83], v[152:155]
    s_waitcnt lgkmcnt(0)
    v_cvt_pk_bf16_f32 v85, v74, v75
    v_mfma_f32_16x16x32_bf16 v[156:159], a[156:159], v[80:83], v[156:159]
    v_exp_f32 v76, v76
    v_mfma_f32_16x16x32_bf16 v[64:67], a[64:67], a[32:35], v[56:59]
    v_mfma_f32_16x16x32_bf16 v[64:67], a[68:71], a[36:39], v[64:67]
    v_exp_f32 v77, v77
    v_mfma_f32_16x16x32_bf16 v[64:67], a[72:75], a[40:43], v[64:67]
    v_cvt_pk_bf16_f32 v86, v76, v77
    v_mfma_f32_16x16x32_bf16 v[64:67], a[76:79], a[44:47], v[64:67]
    v_exp_f32 v78, v78
    v_mfma_f32_16x16x32_bf16 v[68:71], a[80:83], a[32:35], v[56:59]
    v_mfma_f32_16x16x32_bf16 v[68:71], a[84:87], a[36:39], v[68:71]
    v_exp_f32 v79, v79
    v_mfma_f32_16x16x32_bf16 v[68:71], a[88:91], a[40:43], v[68:71]
    v_cvt_pk_bf16_f32 v87, v78, v79
    v_mfma_f32_16x16x32_bf16 v[68:71], a[92:95], a[44:47], v[68:71]
    s_nop 0
    v_exp_f32 v64, v64
    v_mfma_f32_16x16x32_bf16 v[160:163], a[128:131], v[84:87], v[160:163]
    buffer_load_dwordx4 v21, s[24:27], 0 offen offset:1024 nt lds
    v_mfma_f32_16x16x32_bf16 v[164:167], a[132:135], v[84:87], v[164:167]
    v_exp_f32 v65, v65
    v_mfma_f32_16x16x32_bf16 v[168:171], a[136:139], v[84:87], v[168:171]
    v_cvt_pk_bf16_f32 v88, v64, v65
    v_mfma_f32_16x16x32_bf16 v[172:175], a[140:143], v[84:87], v[172:175]
    v_exp_f32 v66, v66
    v_smfmac_f32_16x16x64_bf16 v[96:99], v[112:115], v[80:87], v116
    s_waitcnt vmcnt(4)
    v_mfma_f32_16x16x32_bf16 v[176:179], a[144:147], v[84:87], v[176:179]
    s_barrier
    v_mfma_f32_16x16x32_bf16 v[180:183], a[148:151], v[84:87], v[180:183]
    v_exp_f32 v67, v67
    v_mfma_f32_16x16x32_bf16 v[184:187], a[152:155], v[84:87], v[184:187]
    ds_read_b128 a[96:99], v8 offset:40960
    v_cvt_pk_bf16_f32 v89, v66, v67
    v_mfma_f32_16x16x32_bf16 v[188:191], a[156:159], v[84:87], v[188:191]
    v_exp_f32 v68, v68
    v_mfma_f32_16x16x32_bf16 v[72:75], a[64:67], a[48:51], v[60:63]
    ds_read_b128 a[100:103], v9 offset:40960
    ds_read_b128 a[104:107], v10 offset:40960
    v_mfma_f32_16x16x32_bf16 v[72:75], a[68:71], a[52:55], v[72:75]
    v_exp_f32 v69, v69
    v_mfma_f32_16x16x32_bf16 v[72:75], a[72:75], a[56:59], v[72:75]
    ds_read_b128 a[108:111], v11 offset:40960
    v_cvt_pk_bf16_f32 v90, v68, v69
    v_mfma_f32_16x16x32_bf16 v[72:75], a[76:79], a[60:63], v[72:75]
    v_exp_f32 v70, v70
    v_mfma_f32_16x16x32_bf16 v[76:79], a[80:83], a[48:51], v[60:63]
    ds_read_b128 a[112:115], v8 offset:45056
    v_mfma_f32_16x16x32_bf16 v[76:79], a[84:87], a[52:55], v[76:79]
    s_add_u32 m0, s15, 0
    v_exp_f32 v71, v71
    v_mfma_f32_16x16x32_bf16 v[76:79], a[88:91], a[56:59], v[76:79]
    s_xor_b32 s28, s66, 12288
    buffer_load_dwordx4 v22, s[28:31], 0 offen offset:0 nt lds
    v_cvt_pk_bf16_f32 v91, v70, v71
    v_mfma_f32_16x16x32_bf16 v[76:79], a[92:95], a[60:63], v[76:79]
    v_exp_f32 v72, v72
    v_mfma_f32_16x16x32_bf16 v[192:195], a[128:131], v[88:91], v[192:195]
L_hop1:
    s_cbranch_execz L_hop_back
    ds_read_b128 a[116:119], v9 offset:45056
    ds_read_b128 a[120:123], v10 offset:45056
    v_mfma_f32_16x16x32_bf16 v[196:199], a[132:135], v[88:91], v[196:199]
    v_exp_f32 v73, v73
    v_mfma_f32_16x16x32_bf16 v[200:203], a[136:139], v[88:91], v[200:203]
    ds_read_b128 a[124:127], v11 offset:45056
    v_cvt_pk_bf16_f32 v92, v72, v73
    v_mfma_f32_16x16x32_bf16 v[204:207], a[140:143], v[88:91], v[204:207]
    s_waitcnt vmcnt(3)
    v_exp_f32 v74, v74
    v_mfma_f32_16x16x32_bf16 v[208:211], a[144:147], v[88:91], v[208:211]
    s_barrier
    v_mfma_f32_16x16x32_bf16 v[212:215], a[148:151], v[88:91], v[212:215]
    v_exp_f32 v75, v75
    v_mfma_f32_16x16x32_bf16 v[216:219], a[152:155], v[88:91], v[216:219]
    ds_read_b64_tr_b16 a[160:161], v12 offset:40960
    v_cvt_pk_bf16_f32 v93, v74, v75
    v_mfma_f32_16x16x32_bf16 v[220:223], a[156:159], v[88:91], v[220:223]
    s_waitcnt lgkmcnt(4)
    v_exp_f32 v76, v76
    v_mfma_f32_16x16x32_bf16 v[64:67], a[96:99], a[0:3], v[48:51]
    ds_read_b64_tr_b16 a[162:163], v12 offset:45056
    ds_read_b64_tr_b16 a[164:165], v13 offset:40960
    v_mfma_f32_16x16x32_bf16 v[64:67], a[100:103], a[4:7], v[64:67]
    v_exp_f32 v77, v77
    v_mfma_f32_16x16x32_bf16 v[64:67], a[104:107], a[8:11], v[64:67]
    ds_read_b64_tr_b16 a[166:167], v13 offset:45056
    v_cvt_pk_bf16_f32 v94, v76, v77
    v_mfma_f32_16x16x32_bf16 v[64:67], a[108:111], a[12:15], v[64:67]
    v_exp_f32 v78, v78
    v_mfma_f32_16x16x32_bf16 v[68:71], a[112:115], a[0:3], v[48:51]
    s_waitcnt lgkmcnt(4)
    ds_read_b64_tr_b16 a[168:169], v14 offset:40960
    v_mfma_f32_16x16x32_bf16 v[68:71], a[116:119], a[4:7], v[68:71]
    v_exp_f32 v79, v79
    v_mfma_f32_16x16x32_bf16 v[68:71], a[120:123], a[8:11], v[68:71]
    buffer_load_dwordx4 v23, s[28:31], 0 offen offset:1024 nt lds
    v_cvt_pk_bf16_f32 v95, v78, v79
    v_mfma_f32_16x16x32_bf16 v[68:71], a[124:127], a[12:15], v[68:71]
    v_exp_f32 v64, v64
    v_mfma_f32_16x16x32_bf16 v[224:227], a[128:131], v[92:95], v[224:227]
    ds_read_b64_tr_b16 a[170:171], v14 offset:45056
    ds_read_b64_tr_b16 a[172:173], v15 offset:40960
    v_mfma_f32_16x16x32_bf16 v[228:231], a[132:135], v[92:95], v[228:231]
    v_exp_f32 v65, v65
    v_mfma_f32_16x16x32_bf16 v[232:235], a[136:139], v[92:95], v[232:235]
    ds_read_b64_tr_b16 a[174:175], v15 offset:45056
    v_cvt_pk_bf16_f32 v80, v64, v65
    v_mfma_f32_16x16x32_bf16 v[236:239], a[140:143], v[92:95], v[236:239]
    v_exp_f32 v66, v66
    v_smfmac_f32_16x16x64_bf16 v[100:103], v[112:115], v[88:95], v116
    ds_read_b64_tr_b16 a[176:177], v16 offset:40960
    v_mfma_f32_16x16x32_bf16 v[240:243], a[144:147], v[92:95], v[240:243]
    ds_read_b64_tr_b16 a[178:179], v16 offset:45056
    ds_read_b64_tr_b16 a[180:181], v17 offset:40960
    v_mfma_f32_16x16x32_bf16 v[244:247], a[148:151], v[92:95], v[244:247]
    v_exp_f32 v67, v67
    v_mfma_f32_16x16x32_bf16 v[248:251], a[152:155], v[92:95], v[248:251]
    ds_read_b64_tr_b16 a[182:183], v17 offset:45056
    v_cvt_pk_bf16_f32 v81, v66, v67
    v_mfma_f32_16x16x32_bf16 v[252:255], a[156:159], v[92:95], v[252:255]
    v_exp_f32 v68, v68
    v_mfma_f32_16x16x32_bf16 v[72:75], a[96:99], a[16:19], v[52:55]
    ds_read_b64_tr_b16 a[184:185], v18 offset:40960
    v_mfma_f32_16x16x32_bf16 v[72:75], a[100:103], a[20:23], v[72:75]
    v_exp_f32 v69, v69
    v_mfma_f32_16x16x32_bf16 v[72:75], a[104:107], a[24:27], v[72:75]
    ds_read_b64_tr_b16 a[186:187], v18 offset:45056
    v_cvt_pk_bf16_f32 v82, v68, v69
    v_mfma_f32_16x16x32_bf16 v[72:75], a[108:111], a[28:31], v[72:75]
    s_add_u32 m0, s14, 8192
    v_exp_f32 v70, v70
    v_mfma_f32_16x16x32_bf16 v[76:79], a[112:115], a[16:19], v[52:55]
    s_xor_b32 s24, s65, 14336
    buffer_load_dwordx4 v20, s[24:27], 0 offen offset:0 nt lds
    ds_read_b64_tr_b16 a[188:189], v19 offset:40960
    v_mfma_f32_16x16x32_bf16 v[76:79], a[116:119], a[20:23], v[76:79]
    v_exp_f32 v71, v71
    v_mfma_f32_16x16x32_bf16 v[76:79], a[120:123], a[24:27], v[76:79]
    ds_read_b64_tr_b16 a[190:191], v19 offset:45056
    v_cvt_pk_bf16_f32 v83, v70, v71
    v_mfma_f32_16x16x32_bf16 v[76:79], a[124:127], a[28:31], v[76:79]
    s_waitcnt lgkmcnt(4)
    v_exp_f32 v72, v72
    v_mfma_f32_16x16x32_bf16 v[128:131], a[160:163], v[80:83], v[128:131]
    v_mfma_f32_16x16x32_bf16 v[132:135], a[164:167], v[80:83], v[132:135]
    v_exp_f32 v73, v73
    v_mfma_f32_16x16x32_bf16 v[136:139], a[168:171], v[80:83], v[136:139]
    v_cvt_pk_bf16_f32 v84, v72, v73
    v_mfma_f32_16x16x32_bf16 v[140:143], a[172:175], v[80:83], v[140:143]
    v_exp_f32 v74, v74
    v_mfma_f32_16x16x32_bf16 v[144:147], a[176:179], v[80:83], v[144:147]
    v_mfma_f32_16x16x32_bf16 v[148:151], a[180:183], v[80:83], v[148:151]
    s_waitcnt lgkmcnt(2)
    v_exp_f32 v75, v75
    v_mfma_f32_16x16x32_bf16 v[152:155], a[184:187], v[80:83], v[152:155]
    s_waitcnt lgkmcnt(0)
    v_cvt_pk_bf16_f32 v85, v74, v75
    v_mfma_f32_16x16x32_bf16 v[156:159], a[188:191], v[80:83], v[156:159]
    v_exp_f32 v76, v76
    v_mfma_f32_16x16x32_bf16 v[64:67], a[96:99], a[32:35], v[56:59]
    v_mfma_f32_16x16x32_bf16 v[64:67], a[100:103], a[36:39], v[64:67]
    v_exp_f32 v77, v77
    v_mfma_f32_16x16x32_bf16 v[64:67], a[104:107], a[40:43], v[64:67]
    buffer_load_dwordx4 v21, s[24:27], 0 offen offset:1024 nt lds
    v_cvt_pk_bf16_f32 v86, v76, v77
    v_mfma_f32_16x16x32_bf16 v[64:67], a[108:111], a[44:47], v[64:67]
    v_exp_f32 v78, v78
    v_mfma_f32_16x16x32_bf16 v[68:71], a[112:115], a[32:35], v[56:59]
    v_mfma_f32_16x16x32_bf16 v[68:71], a[116:119], a[36:39], v[68:71]
    v_exp_f32 v79, v79
    v_mfma_f32_16x16x32_bf16 v[68:71], a[120:123], a[40:43], v[68:71]
    v_cvt_pk_bf16_f32 v87, v78, v79
    v_mfma_f32_16x16x32_bf16 v[68:71], a[124:127], a[44:47], v[68:71]
    s_nop 0
    v_exp_f32 v64, v64
    v_mfma_f32_16x16x32_bf16 v[160:163], a[160:163], v[84:87], v[160:163]
    v_mfma_f32_16x16x32_bf16 v[164:167], a[164:167], v[84:87], v[164:167]
    v_exp_f32 v65, v65
    v_mfma_f32_16x16x32_bf16 v[168:171], a[168:171], v[84:87], v[168:171]
    v_cvt_pk_bf16_f32 v88, v64, v65
    v_mfma_f32_16x16x32_bf16 v[172:175], a[172:175], v[84:87], v[172:175]
    v_exp_f32 v66, v66
    v_smfmac_f32_16x16x64_bf16 v[96:99], v[112:115], v[80:87], v116
    s_waitcnt vmcnt(4)
    v_mfma_f32_16x16x32_bf16 v[176:179], a[176:179], v[84:87], v[176:179]
    s_barrier
    v_mfma_f32_16x16x32_bf16 v[180:183], a[180:183], v[84:87], v[180:183]
    v_exp_f32 v67, v67
    v_mfma_f32_16x16x32_bf16 v[184:187], a[184:187], v[84:87], v[184:187]
    ds_read_b128 a[64:67], v8 offset:0
    v_cvt_pk_bf16_f32 v89, v66, v67
    v_mfma_f32_16x16x32_bf16 v[188:191], a[188:191], v[84:87], v[188:191]
    s_add_u32 m0, s15, 8192
    v_exp_f32 v68, v68
    v_mfma_f32_16x16x32_bf16 v[72:75], a[96:99], a[48:51], v[60:63]
    s_xor_b32 s28, s66, 14336
    buffer_load_dwordx4 v22, s[28:31], 0 offen offset:0 nt lds
    ds_read_b128 a[68:71], v9 offset:0
    v_mfma_f32_16x16x32_bf16 v[72:75], a[100:103], a[52:55], v[72:75]
    v_exp_f32 v69, v69
    v_mfma_f32_16x16x32_bf16 v[72:75], a[104:107], a[56:59], v[72:75]
    ds_read_b128 a[72:75], v10 offset:0
    v_cvt_pk_bf16_f32 v90, v68, v69
    v_mfma_f32_16x16x32_bf16 v[72:75], a[108:111], a[60:63], v[72:75]
    v_exp_f32 v70, v70
    v_mfma_f32_16x16x32_bf16 v[76:79], a[112:115], a[48:51], v[60:63]
    ds_read_b128 a[76:79], v11 offset:0
    ds_read_b128 a[80:83], v8 offset:4096
    v_mfma_f32_16x16x32_bf16 v[76:79], a[116:119], a[52:55], v[76:79]
    v_exp_f32 v71, v71
    v_mfma_f32_16x16x32_bf16 v[76:79], a[120:123], a[56:59], v[76:79]
    ds_read_b128 a[84:87], v9 offset:4096
    v_cvt_pk_bf16_f32 v91, v70, v71
    v_mfma_f32_16x16x32_bf16 v[76:79], a[124:127], a[60:63], v[76:79]
    v_exp_f32 v72, v72
    v_mfma_f32_16x16x32_bf16 v[192:195], a[160:163], v[88:91], v[192:195]
    ds_read_b128 a[88:91], v10 offset:4096
    v_mfma_f32_16x16x32_bf16 v[196:199], a[164:167], v[88:91], v[196:199]
    v_exp_f32 v73, v73
    v_mfma_f32_16x16x32_bf16 v[200:203], a[168:171], v[88:91], v[200:203]
    ds_read_b128 a[92:95], v11 offset:4096
    v_cvt_pk_bf16_f32 v92, v72, v73
    v_mfma_f32_16x16x32_bf16 v[204:207], a[172:175], v[88:91], v[204:207]
    s_waitcnt vmcnt(3)
    v_exp_f32 v74, v74
    v_mfma_f32_16x16x32_bf16 v[208:211], a[176:179], v[88:91], v[208:211]
    s_barrier
    v_mfma_f32_16x16x32_bf16 v[212:215], a[180:183], v[88:91], v[212:215]
    v_exp_f32 v75, v75
    v_mfma_f32_16x16x32_bf16 v[216:219], a[184:187], v[88:91], v[216:219]
    ds_read_b64_tr_b16 a[128:129], v12 offset:0
    v_cvt_pk_bf16_f32 v93, v74, v75
    v_mfma_f32_16x16x32_bf16 v[220:223], a[188:191], v[88:91], v[220:223]
    s_waitcnt lgkmcnt(3)
    v_exp_f32 v76, v76
    v_mfma_f32_16x16x32_bf16 v[64:67], a[64:67], a[0:3], v[48:51]
    buffer_load_dwordx4 v23, s[28:31], 0 offen offset:1024 nt lds
    ds_read_b64_tr_b16 a[130:131], v12 offset:4096
    v_mfma_f32_16x16x32_bf16 v[64:67], a[68:71], a[4:7], v[64:67]
    v_exp_f32 v77, v77
    v_mfma_f32_16x16x32_bf16 v[64:67], a[72:75], a[8:11], v[64:67]
    ds_read_b64_tr_b16 a[132:133], v13 offset:0
    v_cvt_pk_bf16_f32 v94, v76, v77
    v_mfma_f32_16x16x32_bf16 v[64:67], a[76:79], a[12:15], v[64:67]
    v_exp_f32 v78, v78
    v_mfma_f32_16x16x32_bf16 v[68:71], a[80:83], a[0:3], v[48:51]
    ds_read_b64_tr_b16 a[134:135], v13 offset:4096
    ds_read_b64_tr_b16 a[136:137], v14 offset:0
    v_mfma_f32_16x16x32_bf16 v[68:71], a[84:87], a[4:7], v[68:71]
    s_waitcnt lgkmcnt(5)
    v_exp_f32 v79, v79
    v_mfma_f32_16x16x32_bf16 v[68:71], a[88:91], a[8:11], v[68:71]
    ds_read_b64_tr_b16 a[138:139], v14 offset:4096
    v_cvt_pk_bf16_f32 v95, v78, v79
    v_mfma_f32_16x16x32_bf16 v[68:71], a[92:95], a[12:15], v[68:71]
    v_exp_f32 v64, v64
    v_mfma_f32_16x16x32_bf16 v[224:227], a[160:163], v[92:95], v[224:227]
    ds_read_b64_tr_b16 a[140:141], v15 offset:0
    v_mfma_f32_16x16x32_bf16 v[228:231], a[164:167], v[92:95], v[228:231]
    v_exp_f32 v65, v65
    v_mfma_f32_16x16x32_bf16 v[232:235], a[168:171], v[92:95], v[232:235]
    ds_read_b64_tr_b16 a[142:143], v15 offset:4096
    v_cvt_pk_bf16_f32 v80, v64, v65
    v_mfma_f32_16x16x32_bf16 v[236:239], a[172:175], v[92:95], v[236:239]
    v_exp_f32 v66, v66
    v_smfmac_f32_16x16x64_bf16 v[100:103], v[112:115], v[88:95], v116
    ds_read_b64_tr_b16 a[144:145], v16 offset:0
    ds_read_b64_tr_b16 a[146:147], v16 offset:4096
    v_mfma_f32_16x16x32_bf16 v[240:243], a[176:179], v[92:95], v[240:243]
    ds_read_b64_tr_b16 a[148:149], v17 offset:0
    v_mfma_f32_16x16x32_bf16 v[244:247], a[180:183], v[92:95], v[244:247]
    s_add_u32 m0, s14, 16384
    v_exp_f32 v67, v67
    v_mfma_f32_16x16x32_bf16 v[248:251], a[184:187], v[92:95], v[248:251]
    s_xor_b32 s24, s65, 16384
    buffer_load_dwordx4 v20, s[24:27], 0 offen offset:0 nt lds
    v_cvt_pk_bf16_f32 v81, v66, v67
    v_mfma_f32_16x16x32_bf16 v[252:255], a[188:191], v[92:95], v[252:255]
    v_exp_f32 v68, v68
    v_mfma_f32_16x16x32_bf16 v[72:75], a[64:67], a[16:19], v[52:55]
    ds_read_b64_tr_b16 a[150:151], v17 offset:4096
    ds_read_b64_tr_b16 a[152:153], v18 offset:0
    v_mfma_f32_16x16x32_bf16 v[72:75], a[68:71], a[20:23], v[72:75]
    v_exp_f32 v69, v69
    v_mfma_f32_16x16x32_bf16 v[72:75], a[72:75], a[24:27], v[72:75]
    ds_read_b64_tr_b16 a[154:155], v18 offset:4096
    v_cvt_pk_bf16_f32 v82, v68, v69
    v_mfma_f32_16x16x32_bf16 v[72:75], a[76:79], a[28:31], v[72:75]
    v_exp_f32 v70, v70
    v_mfma_f32_16x16x32_bf16 v[76:79], a[80:83], a[16:19], v[52:55]
    ds_read_b64_tr_b16 a[156:157], v19 offset:0
    v_mfma_f32_16x16x32_bf16 v[76:79], a[84:87], a[20:23], v[76:79]
    v_exp_f32 v71, v71
    v_mfma_f32_16x16x32_bf16 v[76:79], a[88:91], a[24:27], v[76:79]
    ds_read_b64_tr_b16 a[158:159], v19 offset:4096
    v_cvt_pk_bf16_f32 v83, v70, v71
    v_mfma_f32_16x16x32_bf16 v[76:79], a[92:95], a[28:31], v[76:79]
    s_waitcnt lgkmcnt(5)
    v_exp_f32 v72, v72
    v_mfma_f32_16x16x32_bf16 v[128:131], a[128:131], v[80:83], v[128:131]
    v_mfma_f32_16x16x32_bf16 v[132:135], a[132:135], v[80:83], v[132:135]
    v_exp_f32 v73, v73
    v_mfma_f32_16x16x32_bf16 v[136:139], a[136:139], v[80:83], v[136:139]
    v_cvt_pk_bf16_f32 v84, v72, v73
    v_mfma_f32_16x16x32_bf16 v[140:143], a[140:143], v[80:83], v[140:143]
    v_exp_f32 v74, v74
    v_mfma_f32_16x16x32_bf16 v[144:147], a[144:147], v[80:83], v[144:147]
    s_waitcnt lgkmcnt(3)
    buffer_load_dwordx4 v21, s[24:27], 0 offen offset:1024 nt lds
    v_mfma_f32_16x16x32_bf16 v[148:151], a[148:151], v[80:83], v[148:151]
    s_waitcnt lgkmcnt(2)
    v_exp_f32 v75, v75
    v_mfma_f32_16x16x32_bf16 v[152:155], a[152:155], v[80:83], v[152:155]
    s_waitcnt lgkmcnt(0)
    v_cvt_pk_bf16_f32 v85, v74, v75
    v_mfma_f32_16x16x32_bf16 v[156:159], a[156:159], v[80:83], v[156:159]
    v_exp_f32 v76, v76
    v_mfma_f32_16x16x32_bf16 v[64:67], a[64:67], a[32:35], v[56:59]
    v_mfma_f32_16x16x32_bf16 v[64:67], a[68:71], a[36:39], v[64:67]
    v_exp_f32 v77, v77
    v_mfma_f32_16x16x32_bf16 v[64:67], a[72:75], a[40:43], v[64:67]
    v_cvt_pk_bf16_f32 v86, v76, v77
    v_mfma_f32_16x16x32_bf16 v[64:67], a[76:79], a[44:47], v[64:67]
    v_exp_f32 v78, v78
    v_mfma_f32_16x16x32_bf16 v[68:71], a[80:83], a[32:35], v[56:59]
    v_mfma_f32_16x16x32_bf16 v[68:71], a[84:87], a[36:39], v[68:71]
    v_exp_f32 v79, v79
    v_mfma_f32_16x16x32_bf16 v[68:71], a[88:91], a[40:43], v[68:71]
    v_cvt_pk_bf16_f32 v87, v78, v79
    v_mfma_f32_16x16x32_bf16 v[68:71], a[92:95], a[44:47], v[68:71]
    s_nop 0
    v_exp_f32 v64, v64
    v_mfma_f32_16x16x32_bf16 v[160:163], a[128:131], v[84:87], v[160:163]
    v_mfma_f32_16x16x32_bf16 v[164:167], a[132:135], v[84:87], v[164:167]
    s_add_u32 m0, s15, 16384
    v_exp_f32 v65, v65
    v_mfma_f32_16x16x32_bf16 v[168:171], a[136:139], v[84:87], v[168:171]
    s_xor_b32 s28, s66, 16384
    buffer_load_dwordx4 v22, s[28:31], 0 offen offset:0 nt lds
    v_cvt_pk_bf16_f32 v88, v64, v65
    v_mfma_f32_16x16x32_bf16 v[172:175], a[140:143], v[84:87], v[172:175]
    v_exp_f32 v66, v66
    v_smfmac_f32_16x16x64_bf16 v[96:99], v[112:115], v[80:87], v116
    s_waitcnt vmcnt(5)
    v_mfma_f32_16x16x32_bf16 v[176:179], a[144:147], v[84:87], v[176:179]
    s_barrier
    v_mfma_f32_16x16x32_bf16 v[180:183], a[148:151], v[84:87], v[180:183]
    v_exp_f32 v67, v67
    v_mfma_f32_16x16x32_bf16 v[184:187], a[152:155], v[84:87], v[184:187]
    ds_read_b128 a[96:99], v8 offset:8192
    v_cvt_pk_bf16_f32 v89, v66, v67
    v_mfma_f32_16x16x32_bf16 v[188:191], a[156:159], v[84:87], v[188:191]
    v_exp_f32 v68, v68
    v_mfma_f32_16x16x32_bf16 v[72:75], a[64:67], a[48:51], v[60:63]
    ds_read_b128 a[100:103], v9 offset:8192
    ds_read_b128 a[104:107], v10 offset:8192
    v_mfma_f32_16x16x32_bf16 v[72:75], a[68:71], a[52:55], v[72:75]
    v_exp_f32 v69, v69
    v_mfma_f32_16x16x32_bf16 v[72:75], a[72:75], a[56:59], v[72:75]
    ds_read_b128 a[108:111], v11 offset:8192
    v_cvt_pk_bf16_f32 v90, v68, v69
    v_mfma_f32_16x16x32_bf16 v[72:75], a[76:79], a[60:63], v[72:75]
    v_exp_f32 v70, v70
    v_mfma_f32_16x16x32_bf16 v[76:79], a[80:83], a[48:51], v[60:63]
    ds_read_b128 a[112:115], v8 offset:12288
    v_mfma_f32_16x16x32_bf16 v[76:79], a[84:87], a[52:55], v[76:79]
    v_exp_f32 v71, v71
    v_mfma_f32_16x16x32_bf16 v[76:79], a[88:91], a[56:59], v[76:79]
    ds_read_b128 a[116:119], v9 offset:12288
    v_cvt_pk_bf16_f32 v91, v70, v71
    v_mfma_f32_16x16x32_bf16 v[76:79], a[92:95], a[60:63], v[76:79]
    v_exp_f32 v72, v72
    v_mfma_f32_16x16x32_bf16 v[192:195], a[128:131], v[88:91], v[192:195]
    buffer_load_dwordx4 v23, s[28:31], 0 offen offset:1024 nt lds
    ds_read_b128 a[120:123], v10 offset:12288
    v_mfma_f32_16x16x32_bf16 v[196:199], a[132:135], v[88:91], v[196:199]
    v_exp_f32 v73, v73
    v_mfma_f32_16x16x32_bf16 v[200:203], a[136:139], v[88:91], v[200:203]
    ds_read_b128 a[124:127], v11 offset:12288
    v_cvt_pk_bf16_f32 v92, v72, v73
    v_mfma_f32_16x16x32_bf16 v[204:207], a[140:143], v[88:91], v[204:207]
    s_waitcnt vmcnt(4)
    v_exp_f32 v74, v74
    v_mfma_f32_16x16x32_bf16 v[208:211], a[144:147], v[88:91], v[208:211]
    s_barrier
    v_mfma_f32_16x16x32_bf16 v[212:215], a[148:151], v[88:91], v[212:215]
    v_exp_f32 v75, v75
    v_mfma_f32_16x16x32_bf16 v[216:219], a[152:155], v[88:91], v[216:219]
    ds_read_b64_tr_b16 a[160:161], v12 offset:8192
    v_cvt_pk_bf16_f32 v93, v74, v75
    v_mfma_f32_16x16x32_bf16 v[220:223], a[156:159], v[88:91], v[220:223]
    s_waitcnt lgkmcnt(3)
    v_exp_f32 v76, v76
    v_mfma_f32_16x16x32_bf16 v[64:67], a[96:99], a[0:3], v[48:51]
    ds_read_b64_tr_b16 a[162:163], v12 offset:12288
    ds_read_b64_tr_b16 a[164:165], v13 offset:8192
    v_mfma_f32_16x16x32_bf16 v[64:67], a[100:103], a[4:7], v[64:67]
    v_exp_f32 v77, v77
    v_mfma_f32_16x16x32_bf16 v[64:67], a[104:107], a[8:11], v[64:67]
    ds_read_b64_tr_b16 a[166:167], v13 offset:12288
    v_cvt_pk_bf16_f32 v94, v76, v77
    v_mfma_f32_16x16x32_bf16 v[64:67], a[108:111], a[12:15], v[64:67]
    v_exp_f32 v78, v78
    v_mfma_f32_16x16x32_bf16 v[68:71], a[112:115], a[0:3], v[48:51]
    ds_read_b64_tr_b16 a[168:169], v14 offset:8192
    v_mfma_f32_16x16x32_bf16 v[68:71], a[116:119], a[4:7], v[68:71]
    s_waitcnt lgkmcnt(5)
    s_add_u32 m0, s14, 24576
    v_exp_f32 v79, v79
    v_mfma_f32_16x16x32_bf16 v[68:71], a[120:123], a[8:11], v[68:71]
    s_xor_b32 s24, s65, 18432
    buffer_load_dwordx4 v20, s[24:27], 0 offen offset:0 nt lds
    v_cvt_pk_bf16_f32 v95, v78, v79
    v_mfma_f32_16x16x32_bf16 v[68:71], a[124:127], a[12:15], v[68:71]
    v_exp_f32 v64, v64
    v_mfma_f32_16x16x32_bf16 v[224:227], a[128:131], v[92:95], v[224:227]
    ds_read_b64_tr_b16 a[170:171], v14 offset:12288
    ds_read_b64_tr_b16 a[172:173], v15 offset:8192
    v_mfma_f32_16x16x32_bf16 v[228:231], a[132:135], v[92:95], v[228:231]
    v_exp_f32 v65, v65
    v_mfma_f32_16x16x32_bf16 v[232:235], a[136:139], v[92:95], v[232:235]
    ds_read_b64_tr_b16 a[174:175], v15 offset:12288
    v_cvt_pk_bf16_f32 v80, v64, v65
    v_mfma_f32_16x16x32_bf16 v[236:239], a[140:143], v[92:95], v[236:239]
    v_exp_f32 v66, v66
    v_smfmac_f32_16x16x64_bf16 v[100:103], v[112:115], v[88:95], v116
    ds_read_b64_tr_b16 a[176:177], v16 offset:8192
    v_mfma_f32_16x16x32_bf16 v[240:243], a[144:147], v[92:95], v[240:243]
    ds_read_b64_tr_b16 a[178:179], v16 offset:12288
    ds_read_b64_tr_b16 a[180:181], v17 offset:8192
    v_mfma_f32_16x16x32_bf16 v[244:247], a[148:151], v[92:95], v[244:247]
    v_exp_f32 v67, v67
    v_mfma_f32_16x16x32_bf16 v[248:251], a[152:155], v[92:95], v[248:251]
    ds_read_b64_tr_b16 a[182:183], v17 offset:12288
    v_cvt_pk_bf16_f32 v81, v66, v67
    v_mfma_f32_16x16x32_bf16 v[252:255], a[156:159], v[92:95], v[252:255]
    v_exp_f32 v68, v68
    v_mfma_f32_16x16x32_bf16 v[72:75], a[96:99], a[16:19], v[52:55]
    ds_read_b64_tr_b16 a[184:185], v18 offset:8192
    v_mfma_f32_16x16x32_bf16 v[72:75], a[100:103], a[20:23], v[72:75]
    v_exp_f32 v69, v69
    v_mfma_f32_16x16x32_bf16 v[72:75], a[104:107], a[24:27], v[72:75]
    ds_read_b64_tr_b16 a[186:187], v18 offset:12288
    v_cvt_pk_bf16_f32 v82, v68, v69
    v_mfma_f32_16x16x32_bf16 v[72:75], a[108:111], a[28:31], v[72:75]
    v_exp_f32 v70, v70
    v_mfma_f32_16x16x32_bf16 v[76:79], a[112:115], a[16:19], v[52:55]
    buffer_load_dwordx4 v21, s[24:27], 0 offen offset:1024 nt lds
    ds_read_b64_tr_b16 a[188:189], v19 offset:8192
    v_mfma_f32_16x16x32_bf16 v[76:79], a[116:119], a[20:23], v[76:79]
    v_exp_f32 v71, v71
    v_mfma_f32_16x16x32_bf16 v[76:79], a[120:123], a[24:27], v[76:79]
    ds_read_b64_tr_b16 a[190:191], v19 offset:12288
    v_cvt_pk_bf16_f32 v83, v70, v71
    v_mfma_f32_16x16x32_bf16 v[76:79], a[124:127], a[28:31], v[76:79]
    s_waitcnt lgkmcnt(4)
    v_exp_f32 v72, v72
    v_mfma_f32_16x16x32_bf16 v[128:131], a[160:163], v[80:83], v[128:131]
    v_mfma_f32_16x16x32_bf16 v[132:135], a[164:167], v[80:83], v[132:135]
    v_exp_f32 v73, v73
    v_mfma_f32_16x16x32_bf16 v[136:139], a[168:171], v[80:83], v[136:139]
    v_cvt_pk_bf16_f32 v84, v72, v73
    v_mfma_f32_16x16x32_bf16 v[140:143], a[172:175], v[80:83], v[140:143]
    v_exp_f32 v74, v74
    v_mfma_f32_16x16x32_bf16 v[144:147], a[176:179], v[80:83], v[144:147]
    v_mfma_f32_16x16x32_bf16 v[148:151], a[180:183], v[80:83], v[148:151]
    s_waitcnt lgkmcnt(2)
    v_exp_f32 v75, v75
    v_mfma_f32_16x16x32_bf16 v[152:155], a[184:187], v[80:83], v[152:155]
    s_waitcnt lgkmcnt(0)
    v_cvt_pk_bf16_f32 v85, v74, v75
    v_mfma_f32_16x16x32_bf16 v[156:159], a[188:191], v[80:83], v[156:159]
    s_add_u32 m0, s15, 24576
    v_exp_f32 v76, v76
    v_mfma_f32_16x16x32_bf16 v[64:67], a[96:99], a[32:35], v[56:59]
    s_xor_b32 s28, s66, 18432
    buffer_load_dwordx4 v22, s[28:31], 0 offen offset:0 nt lds
    v_mfma_f32_16x16x32_bf16 v[64:67], a[100:103], a[36:39], v[64:67]
    v_exp_f32 v77, v77
    v_mfma_f32_16x16x32_bf16 v[64:67], a[104:107], a[40:43], v[64:67]
    v_cvt_pk_bf16_f32 v86, v76, v77
    v_mfma_f32_16x16x32_bf16 v[64:67], a[108:111], a[44:47], v[64:67]
    v_exp_f32 v78, v78
    v_mfma_f32_16x16x32_bf16 v[68:71], a[112:115], a[32:35], v[56:59]
    v_mfma_f32_16x16x32_bf16 v[68:71], a[116:119], a[36:39], v[68:71]
    v_exp_f32 v79, v79
    v_mfma_f32_16x16x32_bf16 v[68:71], a[120:123], a[40:43], v[68:71]
    v_cvt_pk_bf16_f32 v87, v78, v79
    v_mfma_f32_16x16x32_bf16 v[68:71], a[124:127], a[44:47], v[68:71]
    s_nop 0
    v_exp_f32 v64, v64
    v_mfma_f32_16x16x32_bf16 v[160:163], a[160:163], v[84:87], v[160:163]
    v_mfma_f32_16x16x32_bf16 v[164:167], a[164:167], v[84:87], v[164:167]
    v_exp_f32 v65, v65
    v_mfma_f32_16x16x32_bf16 v[168:171], a[168:171], v[84:87], v[168:171]
    v_cvt_pk_bf16_f32 v88, v64, v65
    v_mfma_f32_16x16x32_bf16 v[172:175], a[172:175], v[84:87], v[172:175]
    v_exp_f32 v66, v66
    v_smfmac_f32_16x16x64_bf16 v[96:99], v[112:115], v[80:87], v116
    s_waitcnt vmcnt(5)
    v_mfma_f32_16x16x32_bf16 v[176:179], a[176:179], v[84:87], v[176:179]
    s_barrier
    v_mfma_f32_16x16x32_bf16 v[180:183], a[180:183], v[84:87], v[180:183]
    v_exp_f32 v67, v67
    v_mfma_f32_16x16x32_bf16 v[184:187], a[184:187], v[84:87], v[184:187]
    buffer_load_dwordx4 v23, s[28:31], 0 offen offset:1024 nt lds
    v_cvt_pk_bf16_f32 v89, v66, v67
    v_mfma_f32_16x16x32_bf16 v[188:191], a[188:191], v[84:87], v[188:191]
    v_exp_f32 v68, v68
    v_mfma_f32_16x16x32_bf16 v[72:75], a[96:99], a[48:51], v[60:63]
    ds_read_b128 a[64:67], v8 offset:16384
    ds_read_b128 a[68:71], v9 offset:16384
    v_mfma_f32_16x16x32_bf16 v[72:75], a[100:103], a[52:55], v[72:75]
    v_exp_f32 v69, v69
    v_mfma_f32_16x16x32_bf16 v[72:75], a[104:107], a[56:59], v[72:75]
    ds_read_b128 a[72:75], v10 offset:16384
    v_cvt_pk_bf16_f32 v90, v68, v69
    v_mfma_f32_16x16x32_bf16 v[72:75], a[108:111], a[60:63], v[72:75]
    v_exp_f32 v70, v70
    v_mfma_f32_16x16x32_bf16 v[76:79], a[112:115], a[48:51], v[60:63]
    ds_read_b128 a[76:79], v11 offset:16384
    v_mfma_f32_16x16x32_bf16 v[76:79], a[116:119], a[52:55], v[76:79]
    v_exp_f32 v71, v71
    v_mfma_f32_16x16x32_bf16 v[76:79], a[120:123], a[56:59], v[76:79]
    ds_read_b128 a[80:83], v8 offset:20480
    v_cvt_pk_bf16_f32 v91, v70, v71
    v_mfma_f32_16x16x32_bf16 v[76:79], a[124:127], a[60:63], v[76:79]
    v_exp_f32 v72, v72
    v_mfma_f32_16x16x32_bf16 v[192:195], a[160:163], v[88:91], v[192:195]
    ds_read_b128 a[84:87], v9 offset:20480
    ds_read_b128 a[88:91], v10 offset:20480
    v_mfma_f32_16x16x32_bf16 v[196:199], a[164:167], v[88:91], v[196:199]
    v_exp_f32 v73, v73
    v_mfma_f32_16x16x32_bf16 v[200:203], a[168:171], v[88:91], v[200:203]
    ds_read_b128 a[92:95], v11 offset:20480
    v_cvt_pk_bf16_f32 v92, v72, v73
    v_mfma_f32_16x16x32_bf16 v[204:207], a[172:175], v[88:91], v[204:207]
    s_add_u32 m0, s14, 32768
    s_waitcnt vmcnt(4)
    v_exp_f32 v74, v74
    v_mfma_f32_16x16x32_bf16 v[208:211], a[176:179], v[88:91], v[208:211]
    s_xor_b32 s24, s65, 20480
    s_barrier
    buffer_load_dwordx4 v20, s[24:27], 0 offen offset:0 nt lds
    v_mfma_f32_16x16x32_bf16 v[212:215], a[180:183], v[88:91], v[212:215]
    v_exp_f32 v75, v75
    v_mfma_f32_16x16x32_bf16 v[216:219], a[184:187], v[88:91], v[216:219]
    ds_read_b64_tr_b16 a[128:129], v12 offset:16384
    v_cvt_pk_bf16_f32 v93, v74, v75
    v_mfma_f32_16x16x32_bf16 v[220:223], a[188:191], v[88:91], v[220:223]
    s_waitcnt lgkmcnt(4)
    v_exp_f32 v76, v76
    v_mfma_f32_16x16x32_bf16 v[64:67], a[64:67], a[0:3], v[48:51]
    ds_read_b64_tr_b16 a[130:131], v12 offset:20480
    v_mfma_f32_16x16x32_bf16 v[64:67], a[68:71], a[4:7], v[64:67]
    v_exp_f32 v77, v77
    v_mfma_f32_16x16x32_bf16 v[64:67], a[72:75], a[8:11], v[64:67]
    ds_read_b64_tr_b16 a[132:133], v13 offset:16384
    v_cvt_pk_bf16_f32 v94, v76, v77
    v_mfma_f32_16x16x32_bf16 v[64:67], a[76:79], a[12:15], v[64:67]
    v_exp_f32 v78, v78
    v_mfma_f32_16x16x32_bf16 v[68:71], a[80:83], a[0:3], v[48:51]
    s_waitcnt lgkmcnt(3)
    ds_read_b64_tr_b16 a[134:135], v13 offset:20480
    ds_read_b64_tr_b16 a[136:137], v14 offset:16384
    v_mfma_f32_16x16x32_bf16 v[68:71], a[84:87], a[4:7], v[68:71]
    v_exp_f32 v79, v79
    v_mfma_f32_16x16x32_bf16 v[68:71], a[88:91], a[8:11], v[68:71]
    ds_read_b64_tr_b16 a[138:139], v14 offset:20480
    v_cvt_pk_bf16_f32 v95, v78, v79
    v_mfma_f32_16x16x32_bf16 v[68:71], a[92:95], a[12:15], v[68:71]
    v_exp_f32 v64, v64
    v_mfma_f32_16x16x32_bf16 v[224:227], a[160:163], v[92:95], v[224:227]
    buffer_load_dwordx4 v21, s[24:27], 0 offen offset:1024 nt lds
    ds_read_b64_tr_b16 a[140:141], v15 offset:16384
    v_mfma_f32_16x16x32_bf16 v[228:231], a[164:167], v[92:95], v[228:231]
    v_exp_f32 v65, v65
    v_mfma_f32_16x16x32_bf16 v[232:235], a[168:171], v[92:95], v[232:235]
    ds_read_b64_tr_b16 a[142:143], v15 offset:20480
    v_cvt_pk_bf16_f32 v80, v64, v65
    v_mfma_f32_16x16x32_bf16 v[236:239], a[172:175], v[92:95], v[236:239]
    v_exp_f32 v66, v66
    v_smfmac_f32_16x16x64_bf16 v[100:103], v[112:115], v[88:95], v116
    ds_read_b64_tr_b16 a[144:145], v16 offset:16384
    v_mfma_f32_16x16x32_bf16 v[240:243], a[176:179], v[92:95], v[240:243]
    ds_read_b64_tr_b16 a[146:147], v16 offset:20480
    ds_read_b64_tr_b16 a[148:149], v17 offset:16384
    v_mfma_f32_16x16x32_bf16 v[244:247], a[180:183], v[92:95], v[244:247]
    v_exp_f32 v67, v67
    v_mfma_f32_16x16x32_bf16 v[248:251], a[184:187], v[92:95], v[248:251]
    ds_read_b64_tr_b16 a[150:151], v17 offset:20480
    v_cvt_pk_bf16_f32 v81, v66, v67
    v_mfma_f32_16x16x32_bf16 v[252:255], a[188:191], v[92:95], v[252:255]
    v_exp_f32 v68, v68
    v_mfma_f32_16x16x32_bf16 v[72:75], a[64:67], a[16:19], v[52:55]
    ds_read_b64_tr_b16 a[152:153], v18 offset:16384
    v_mfma_f32_16x16x32_bf16 v[72:75], a[68:71], a[20:23], v[72:75]
    v_exp_f32 v69, v69
    v_mfma_f32_16x16x32_bf16 v[72:75], a[72:75], a[24:27], v[72:75]
    ds_read_b64_tr_b16 a[154:155], v18 offset:20480
    v_cvt_pk_bf16_f32 v82, v68, v69
    v_mfma_f32_16x16x32_bf16 v[72:75], a[76:79], a[28:31], v[72:75]
    v_exp_f32 v70, v70
    v_mfma_f32_16x16x32_bf16 v[76:79], a[80:83], a[16:19], v[52:55]
    ds_read_b64_tr_b16 a[156:157], v19 offset:16384
    ds_read_b64_tr_b16 a[158:159], v19 offset:20480
    v_mfma_f32_16x16x32_bf16 v[76:79], a[84:87], a[20:23], v[76:79]
    s_add_u32 m0, s15, 32768
    v_exp_f32 v71, v71
    v_mfma_f32_16x16x32_bf16 v[76:79], a[88:91], a[24:27], v[76:79]
    s_xor_b32 s28, s66, 20480
    buffer_load_dwordx4 v22, s[28:31], 0 offen offset:0 nt lds
    v_cvt_pk_bf16_f32 v83, v70, v71
    v_mfma_f32_16x16x32_bf16 v[76:79], a[92:95], a[28:31], v[76:79]
    s_waitcnt lgkmcnt(4)
    v_exp_f32 v72, v72
    v_mfma_f32_16x16x32_bf16 v[128:131], a[128:131], v[80:83], v[128:131]
    v_mfma_f32_16x16x32_bf16 v[132:135], a[132:135], v[80:83], v[132:135]
    v_exp_f32 v73, v73
    v_mfma_f32_16x16x32_bf16 v[136:139], a[136:139], v[80:83], v[136:139]
    v_cvt_pk_bf16_f32 v84, v72, v73
    v_mfma_f32_16x16x32_bf16 v[140:143], a[140:143], v[80:83], v[140:143]
    v_exp_f32 v74, v74
    v_mfma_f32_16x16x32_bf16 v[144:147], a[144:147], v[80:83], v[144:147]
    v_mfma_f32_16x16x32_bf16 v[148:151], a[148:151], v[80:83], v[148:151]
    s_waitcnt lgkmcnt(2)
    v_exp_f32 v75, v75
    v_mfma_f32_16x16x32_bf16 v[152:155], a[152:155], v[80:83], v[152:155]
    s_waitcnt lgkmcnt(0)
    v_cvt_pk_bf16_f32 v85, v74, v75
    v_mfma_f32_16x16x32_bf16 v[156:159], a[156:159], v[80:83], v[156:159]
    v_exp_f32 v76, v76
    v_mfma_f32_16x16x32_bf16 v[64:67], a[64:67], a[32:35], v[56:59]
    v_mfma_f32_16x16x32_bf16 v[64:67], a[68:71], a[36:39], v[64:67]
    v_exp_f32 v77, v77
    v_mfma_f32_16x16x32_bf16 v[64:67], a[72:75], a[40:43], v[64:67]
    v_cvt_pk_bf16_f32 v86, v76, v77
    v_mfma_f32_16x16x32_bf16 v[64:67], a[76:79], a[44:47], v[64:67]
    v_exp_f32 v78, v78
    v_mfma_f32_16x16x32_bf16 v[68:71], a[80:83], a[32:35], v[56:59]
    buffer_load_dwordx4 v23, s[28:31], 0 offen offset:1024 nt lds
    v_mfma_f32_16x16x32_bf16 v[68:71], a[84:87], a[36:39], v[68:71]
    v_exp_f32 v79, v79
    v_mfma_f32_16x16x32_bf16 v[68:71], a[88:91], a[40:43], v[68:71]
    v_cvt_pk_bf16_f32 v87, v78, v79
    v_mfma_f32_16x16x32_bf16 v[68:71], a[92:95], a[44:47], v[68:71]
    v_exp_f32 v64, v64
    v_mfma_f32_16x16x32_bf16 v[160:163], a[128:131], v[84:87], v[160:163]
    v_mfma_f32_16x16x32_bf16 v[164:167], a[132:135], v[84:87], v[164:167]
    v_exp_f32 v65, v65
    v_mfma_f32_16x16x32_bf16 v[168:171], a[136:139], v[84:87], v[168:171]
L_hop2:
    s_cbranch_execz L_hop_back
    v_cvt_pk_bf16_f32 v88, v64, v65
    v_mfma_f32_16x16x32_bf16 v[172:175], a[140:143], v[84:87], v[172:175]
    v_exp_f32 v66, v66
    v_smfmac_f32_16x16x64_bf16 v[96:99], v[112:115], v[80:87], v116
    s_waitcnt vmcnt(6)
    v_mfma_f32_16x16x32_bf16 v[176:179], a[144:147], v[84:87], v[176:179]
    s_barrier
    v_mfma_f32_16x16x32_bf16 v[180:183], a[148:151], v[84:87], v[180:183]
    v_exp_f32 v67, v67
    v_mfma_f32_16x16x32_bf16 v[184:187], a[152:155], v[84:87], v[184:187]
    ds_read_b128 a[96:99], v8 offset:24576
    v_cvt_pk_bf16_f32 v89, v66, v67
    v_mfma_f32_16x16x32_bf16 v[188:191], a[156:159], v[84:87], v[188:191]
    s_add_u32 m0, s14, 40960
    v_exp_f32 v68, v68
    v_mfma_f32_16x16x32_bf16 v[72:75], a[64:67], a[48:51], v[60:63]
    s_xor_b32 s24, s65, 22528
    buffer_load_dwordx4 v20, s[24:27], 0 offen offset:0 nt lds
    ds_read_b128 a[100:103], v9 offset:24576
    v_mfma_f32_16x16x32_bf16 v[72:75], a[68:71], a[52:55], v[72:75]
    v_exp_f32 v69, v69
    v_mfma_f32_16x16x32_bf16 v[72:75], a[72:75], a[56:59], v[72:75]
    ds_read_b128 a[104:107], v10 offset:24576
    v_cvt_pk_bf16_f32 v90, v68, v69
    v_mfma_f32_16x16x32_bf16 v[72:75], a[76:79], a[60:63], v[72:75]
    v_exp_f32 v70, v70
    v_mfma_f32_16x16x32_bf16 v[76:79], a[80:83], a[48:51], v[60:63]
    ds_read_b128 a[108:111], v11 offset:24576
    ds_read_b128 a[112:115], v8 offset:28672
    v_mfma_f32_16x16x32_bf16 v[76:79], a[84:87], a[52:55], v[76:79]
    v_exp_f32 v71, v71
    v_mfma_f32_16x16x32_bf16 v[76:79], a[88:91], a[56:59], v[76:79]
    ds_read_b128 a[116:119], v9 offset:28672
    v_cvt_pk_bf16_f32 v91, v70, v71
    v_mfma_f32_16x16x32_bf16 v[76:79], a[92:95], a[60:63], v[76:79]
    v_exp_f32 v72, v72
    v_mfma_f32_16x16x32_bf16 v[192:195], a[128:131], v[88:91], v[192:195]
    ds_read_b128 a[120:123], v10 offset:28672
    v_mfma_f32_16x16x32_bf16 v[196:199], a[132:135], v[88:91], v[196:199]
    v_exp_f32 v73, v73
    v_mfma_f32_16x16x32_bf16 v[200:203], a[136:139], v[88:91], v[200:203]
    ds_read_b128 a[124:127], v11 offset:28672
    v_cvt_pk_bf16_f32 v92, v72, v73
    v_mfma_f32_16x16x32_bf16 v[204:207], a[140:143], v[88:91], v[204:207]
    s_waitcnt vmcnt(5)
    v_exp_f32 v74, v74
    v_mfma_f32_16x16x32_bf16 v[208:211], a[144:147], v[88:91], v[208:211]
    s_barrier
    buffer_load_dwordx4 v21, s[24:27], 0 offen offset:1024 nt lds
    v_mfma_f32_16x16x32_bf16 v[212:215], a[148:151], v[88:91], v[212:215]
    v_exp_f32 v75, v75
    v_mfma_f32_16x16x32_bf16 v[216:219], a[152:155], v[88:91], v[216:219]
    ds_read_b64_tr_b16 a[160:161], v12 offset:24576
    v_cvt_pk_bf16_f32 v93, v74, v75
    v_mfma_f32_16x16x32_bf16 v[220:223], a[156:159], v[88:91], v[220:223]
    s_waitcnt lgkmcnt(3)
    v_exp_f32 v76, v76
    v_mfma_f32_16x16x32_bf16 v[64:67], a[96:99], a[0:3], v[48:51]
    ds_read_b64_tr_b16 a[162:163], v12 offset:28672
    ds_read_b64_tr_b16 a[164:165], v13 offset:24576
    v_mfma_f32_16x16x32_bf16 v[64:67], a[100:103], a[4:7], v[64:67]
    v_exp_f32 v77, v77
    v_mfma_f32_16x16x32_bf16 v[64:67], a[104:107], a[8:11], v[64:67]
    ds_read_b64_tr_b16 a[166:167], v13 offset:28672
    v_cvt_pk_bf16_f32 v94, v76, v77
    v_mfma_f32_16x16x32_bf16 v[64:67], a[108:111], a[12:15], v[64:67]
    v_exp_f32 v78, v78
    v_mfma_f32_16x16x32_bf16 v[68:71], a[112:115], a[0:3], v[48:51]
    ds_read_b64_tr_b16 a[168:169], v14 offset:24576
    v_mfma_f32_16x16x32_bf16 v[68:71], a[116:119], a[4:7], v[68:71]
    s_waitcnt lgkmcnt(5)
    v_exp_f32 v79, v79
    v_mfma_f32_16x16x32_bf16 v[68:71], a[120:123], a[8:11], v[68:71]
    ds_read_b64_tr_b16 a[170:171], v14 offset:28672
    v_cvt_pk_bf16_f32 v95, v78, v79
    v_mfma_f32_16x16x32_bf16 v[68:71], a[124:127], a[12:15], v[68:71]
    v_exp_f32 v64, v64
    v_mfma_f32_16x16x32_bf16 v[224:227], a[128:131], v[92:95], v[224:227]
    ds_read_b64_tr_b16 a[172:173], v15 offset:24576
    ds_read_b64_tr_b16 a[174:175], v15 offset:28672
    v_mfma_f32_16x16x32_bf16 v[228:231], a[132:135], v[92:95], v[228:231]
    s_add_u32 m0, s15, 40960
    v_exp_f32 v65, v65
    v_mfma_f32_16x16x32_bf16 v[232:235], a[136:139], v[92:95], v[232:235]
    s_xor_b32 s28, s66, 22528
    buffer_load_dwordx4 v22, s[28:31], 0 offen offset:0 nt lds
    v_cvt_pk_bf16_f32 v80, v64, v65
    v_mfma_f32_16x16x32_bf16 v[236:239], a[140:143], v[92:95], v[236:239]
    v_exp_f32 v66, v66
    v_smfmac_f32_16x16x64_bf16 v[100:103], v[112:115], v[88:95], v116
    ds_read_b64_tr_b16 a[176:177], v16 offset:24576
    v_mfma_f32_16x16x32_bf16 v[240:243], a[144:147], v[92:95], v[240:243]
    ds_read_b64_tr_b16 a[178:179], v16 offset:28672
    ds_read_b64_tr_b16 a[180:181], v17 offset:24576
    v_mfma_f32_16x16x32_bf16 v[244:247], a[148:151], v[92:95], v[244:247]
    v_exp_f32 v67, v67
    v_mfma_f32_16x16x32_bf16 v[248:251], a[152:155], v[92:95], v[248:251]
    ds_read_b64_tr_b16 a[182:183], v17 offset:28672
    v_cvt_pk_bf16_f32 v81, v66, v67
    v_mfma_f32_16x16x32_bf16 v[252:255], a[156:159], v[92:95], v[252:255]
    v_exp_f32 v68, v68
    v_mfma_f32_16x16x32_bf16 v[72:75], a[96:99], a[16:19], v[52:55]
    ds_read_b64_tr_b16 a[184:185], v18 offset:24576
    v_mfma_f32_16x16x32_bf16 v[72:75], a[100:103], a[20:23], v[72:75]
    v_exp_f32 v69, v69
    v_mfma_f32_16x16x32_bf16 v[72:75], a[104:107], a[24:27], v[72:75]
    ds_read_b64_tr_b16 a[186:187], v18 offset:28672
    v_cvt_pk_bf16_f32 v82, v68, v69
    v_mfma_f32_16x16x32_bf16 v[72:75], a[108:111], a[28:31], v[72:75]
    v_exp_f32 v70, v70
    v_mfma_f32_16x16x32_bf16 v[76:79], a[112:115], a[16:19], v[52:55]
    ds_read_b64_tr_b16 a[188:189], v19 offset:24576
    ds_read_b64_tr_b16 a[190:191], v19 offset:28672
    v_mfma_f32_16x16x32_bf16 v[76:79], a[116:119], a[20:23], v[76:79]
    v_exp_f32 v71, v71
    v_mfma_f32_16x16x32_bf16 v[76:79], a[120:123], a[24:27], v[76:79]
    buffer_load_dwordx4 v23, s[28:31], 0 offen offset:1024 nt lds
    v_cvt_pk_bf16_f32 v83, v70, v71
    v_mfma_f32_16x16x32_bf16 v[76:79], a[124:127], a[28:31], v[76:79]
    s_waitcnt lgkmcnt(4)
    v_exp_f32 v72, v72
    v_mfma_f32_16x16x32_bf16 v[128:131], a[160:163], v[80:83], v[128:131]
    v_mfma_f32_16x16x32_bf16 v[132:135], a[164:167], v[80:83], v[132:135]
    v_exp_f32 v73, v73
    v_mfma_f32_16x16x32_bf16 v[136:139], a[168:171], v[80:83], v[136:139]
    v_cvt_pk_bf16_f32 v84, v72, v73
    v_mfma_f32_16x16x32_bf16 v[140:143], a[172:175], v[80:83], v[140:143]
    v_exp_f32 v74, v74
    v_mfma_f32_16x16x32_bf16 v[144:147], a[176:179], v[80:83], v[144:147]
    v_mfma_f32_16x16x32_bf16 v[148:151], a[180:183], v[80:83], v[148:151]
    s_waitcnt lgkmcnt(2)
    v_exp_f32 v75, v75
    v_mfma_f32_16x16x32_bf16 v[152:155], a[184:187], v[80:83], v[152:155]
    s_waitcnt lgkmcnt(0)
    v_cvt_pk_bf16_f32 v85, v74, v75
    v_mfma_f32_16x16x32_bf16 v[156:159], a[188:191], v[80:83], v[156:159]
    v_exp_f32 v76, v76
    v_mfma_f32_16x16x32_bf16 v[64:67], a[96:99], a[32:35], v[56:59]
    v_mfma_f32_16x16x32_bf16 v[64:67], a[100:103], a[36:39], v[64:67]
    s_add_u32 m0, s14, 0
    v_exp_f32 v77, v77
    v_mfma_f32_16x16x32_bf16 v[64:67], a[104:107], a[40:43], v[64:67]
    s_xor_b32 s24, s65, 24576
    buffer_load_dwordx4 v20, s[24:27], 0 offen offset:0 nt lds
    v_cvt_pk_bf16_f32 v86, v76, v77
    v_mfma_f32_16x16x32_bf16 v[64:67], a[108:111], a[44:47], v[64:67]
    v_exp_f32 v78, v78
    v_mfma_f32_16x16x32_bf16 v[68:71], a[112:115], a[32:35], v[56:59]
    v_mfma_f32_16x16x32_bf16 v[68:71], a[116:119], a[36:39], v[68:71]
    v_exp_f32 v79, v79
    v_mfma_f32_16x16x32_bf16 v[68:71], a[120:123], a[40:43], v[68:71]
    v_cvt_pk_bf16_f32 v87, v78, v79
    v_mfma_f32_16x16x32_bf16 v[68:71], a[124:127], a[44:47], v[68:71]
    s_nop 0
    v_exp_f32 v64, v64
    v_mfma_f32_16x16x32_bf16 v[160:163], a[160:163], v[84:87], v[160:163]
    v_mfma_f32_16x16x32_bf16 v[164:167], a[164:167], v[84:87], v[164:167]
    v_exp_f32 v65, v65
    v_mfma_f32_16x16x32_bf16 v[168:171], a[168:171], v[84:87], v[168:171]
    v_cvt_pk_bf16_f32 v88, v64, v65
    v_mfma_f32_16x16x32_bf16 v[172:175], a[172:175], v[84:87], v[172:175]
    v_exp_f32 v66, v66
    v_smfmac_f32_16x16x64_bf16 v[96:99], v[112:115], v[80:87], v116
    s_waitcnt vmcnt(7)
    v_mfma_f32_16x16x32_bf16 v[176:179], a[176:179], v[84:87], v[176:179]
    s_barrier
    v_mfma_f32_16x16x32_bf16 v[180:183], a[180:183], v[84:87], v[180:183]
    v_exp_f32 v67, v67
    v_mfma_f32_16x16x32_bf16 v[184:187], a[184:187], v[84:87], v[184:187]
    ds_read_b128 a[64:67], v8 offset:32768
    v_cvt_pk_bf16_f32 v89, v66, v67
    v_mfma_f32_16x16x32_bf16 v[188:191], a[188:191], v[84:87], v[188:191]
    v_exp_f32 v68, v68
    v_mfma_f32_16x16x32_bf16 v[72:75], a[96:99], a[48:51], v[60:63]
    buffer_load_dwordx4 v21, s[24:27], 0 offen offset:1024 nt lds
    ds_read_b128 a[68:71], v9 offset:32768
    v_mfma_f32_16x16x32_bf16 v[72:75], a[100:103], a[52:55], v[72:75]
    v_exp_f32 v69, v69
    v_mfma_f32_16x16x32_bf16 v[72:75], a[104:107], a[56:59], v[72:75]
    ds_read_b128 a[72:75], v10 offset:32768
    v_cvt_pk_bf16_f32 v90, v68, v69
    v_mfma_f32_16x16x32_bf16 v[72:75], a[108:111], a[60:63], v[72:75]
    v_exp_f32 v70, v70
    v_mfma_f32_16x16x32_bf16 v[76:79], a[112:115], a[48:51], v[60:63]
    ds_read_b128 a[76:79], v11 offset:32768
    ds_read_b128 a[80:83], v8 offset:36864
    v_mfma_f32_16x16x32_bf16 v[76:79], a[116:119], a[52:55], v[76:79]
    v_exp_f32 v71, v71
    v_mfma_f32_16x16x32_bf16 v[76:79], a[120:123], a[56:59], v[76:79]
    ds_read_b128 a[84:87], v9 offset:36864
    v_cvt_pk_bf16_f32 v91, v70, v71
    v_mfma_f32_16x16x32_bf16 v[76:79], a[124:127], a[60:63], v[76:79]
    v_exp_f32 v72, v72
    v_mfma_f32_16x16x32_bf16 v[192:195], a[160:163], v[88:91], v[192:195]
    ds_read_b128 a[88:91], v10 offset:36864
    v_mfma_f32_16x16x32_bf16 v[196:199], a[164:167], v[88:91], v[196:199]
    v_exp_f32 v73, v73
    v_mfma_f32_16x16x32_bf16 v[200:203], a[168:171], v[88:91], v[200:203]
    ds_read_b128 a[92:95], v11 offset:36864
    v_cvt_pk_bf16_f32 v92, v72, v73
    v_mfma_f32_16x16x32_bf16 v[204:207], a[172:175], v[88:91], v[204:207]
    s_add_u32 m0, s15, 0
    s_waitcnt vmcnt(6)
    v_exp_f32 v74, v74
    v_mfma_f32_16x16x32_bf16 v[208:211], a[176:179], v[88:91], v[208:211]
    s_xor_b32 s28, s66, 24576
    s_barrier
    buffer_load_dwordx4 v22, s[28:31], 0 offen offset:0 nt lds
    v_mfma_f32_16x16x32_bf16 v[212:215], a[180:183], v[88:91], v[212:215]
    v_exp_f32 v75, v75
    v_mfma_f32_16x16x32_bf16 v[216:219], a[184:187], v[88:91], v[216:219]
    ds_read_b64_tr_b16 a[128:129], v12 offset:32768
    v_cvt_pk_bf16_f32 v93, v74, v75
    v_mfma_f32_16x16x32_bf16 v[220:223], a[188:191], v[88:91], v[220:223]
    s_waitcnt lgkmcnt(3)
    v_exp_f32 v76, v76
    v_mfma_f32_16x16x32_bf16 v[64:67], a[64:67], a[0:3], v[48:51]
    ds_read_b64_tr_b16 a[130:131], v12 offset:36864
    ds_read_b64_tr_b16 a[132:133], v13 offset:32768
    v_mfma_f32_16x16x32_bf16 v[64:67], a[68:71], a[4:7], v[64:67]
    v_exp_f32 v77, v77
    v_mfma_f32_16x16x32_bf16 v[64:67], a[72:75], a[8:11], v[64:67]
    ds_read_b64_tr_b16 a[134:135], v13 offset:36864
    v_cvt_pk_bf16_f32 v94, v76, v77
    v_mfma_f32_16x16x32_bf16 v[64:67], a[76:79], a[12:15], v[64:67]
    v_exp_f32 v78, v78
    v_mfma_f32_16x16x32_bf16 v[68:71], a[80:83], a[0:3], v[48:51]
    ds_read_b64_tr_b16 a[136:137], v14 offset:32768
    v_mfma_f32_16x16x32_bf16 v[68:71], a[84:87], a[4:7], v[68:71]
    s_waitcnt lgkmcnt(5)
    v_exp_f32 v79, v79
    v_mfma_f32_16x16x32_bf16 v[68:71], a[88:91], a[8:11], v[68:71]
    ds_read_b64_tr_b16 a[138:139], v14 offset:36864
    v_cvt_pk_bf16_f32 v95, v78, v79
    v_mfma_f32_16x16x32_bf16 v[68:71], a[92:95], a[12:15], v[68:71]
    v_exp_f32 v64, v64
    v_mfma_f32_16x16x32_bf16 v[224:227], a[160:163], v[92:95], v[224:227]
    ds_read_b64_tr_b16 a[140:141], v15 offset:32768
    ds_read_b64_tr_b16 a[142:143], v15 offset:36864
    v_mfma_f32_16x16x32_bf16 v[228:231], a[164:167], v[92:95], v[228:231]
    v_exp_f32 v65, v65
    v_mfma_f32_16x16x32_bf16 v[232:235], a[168:171], v[92:95], v[232:235]
    buffer_load_dwordx4 v23, s[28:31], 0 offen offset:1024 nt lds
    v_cvt_pk_bf16_f32 v80, v64, v65
    v_mfma_f32_16x16x32_bf16 v[236:239], a[172:175], v[92:95], v[236:239]
    v_exp_f32 v66, v66
    v_smfmac_f32_16x16x64_bf16 v[100:103], v[112:115], v[88:95], v116
    ds_read_b64_tr_b16 a[144:145], v16 offset:32768
    v_mfma_f32_16x16x32_bf16 v[240:243], a[176:179], v[92:95], v[240:243]
    ds_read_b64_tr_b16 a[146:147], v16 offset:36864
    ds_read_b64_tr_b16 a[148:149], v17 offset:32768
    v_mfma_f32_16x16x32_bf16 v[244:247], a[180:183], v[92:95], v[244:247]
    v_exp_f32 v67, v67
    v_mfma_f32_16x16x32_bf16 v[248:251], a[184:187], v[92:95], v[248:251]
    ds_read_b64_tr_b16 a[150:151], v17 offset:36864
    v_cvt_pk_bf16_f32 v81, v66, v67
    v_mfma_f32_16x16x32_bf16 v[252:255], a[188:191], v[92:95], v[252:255]
    v_exp_f32 v68, v68
    v_mfma_f32_16x16x32_bf16 v[72:75], a[64:67], a[16:19], v[52:55]
    ds_read_b64_tr_b16 a[152:153], v18 offset:32768
    v_mfma_f32_16x16x32_bf16 v[72:75], a[68:71], a[20:23], v[72:75]
    v_exp_f32 v69, v69
    v_mfma_f32_16x16x32_bf16 v[72:75], a[72:75], a[24:27], v[72:75]
    ds_read_b64_tr_b16 a[154:155], v18 offset:36864
    v_cvt_pk_bf16_f32 v82, v68, v69
    v_mfma_f32_16x16x32_bf16 v[72:75], a[76:79], a[28:31], v[72:75]
    v_exp_f32 v70, v70
    v_mfma_f32_16x16x32_bf16 v[76:79], a[80:83], a[16:19], v[52:55]
    ds_read_b64_tr_b16 a[156:157], v19 offset:32768
    ds_read_b64_tr_b16 a[158:159], v19 offset:36864
    v_mfma_f32_16x16x32_bf16 v[76:79], a[84:87], a[20:23], v[76:79]
    s_add_u32 m0, s14, 8192
    v_exp_f32 v71, v71
    v_mfma_f32_16x16x32_bf16 v[76:79], a[88:91], a[24:27], v[76:79]
    s_xor_b32 s24, s65, 26624
    buffer_load_dwordx4 v20, s[24:27], 0 offen offset:0 nt lds
    v_cvt_pk_bf16_f32 v83, v70, v71
    v_mfma_f32_16x16x32_bf16 v[76:79], a[92:95], a[28:31], v[76:79]
    s_waitcnt lgkmcnt(4)
    v_exp_f32 v72, v72
    v_mfma_f32_16x16x32_bf16 v[128:131], a[128:131], v[80:83], v[128:131]
    v_mfma_f32_16x16x32_bf16 v[132:135], a[132:135], v[80:83], v[132:135]
    v_exp_f32 v73, v73
    v_mfma_f32_16x16x32_bf16 v[136:139], a[136:139], v[80:83], v[136:139]
    v_cvt_pk_bf16_f32 v84, v72, v73
    v_mfma_f32_16x16x32_bf16 v[140:143], a[140:143], v[80:83], v[140:143]
    v_exp_f32 v74, v74
    v_mfma_f32_16x16x32_bf16 v[144:147], a[144:147], v[80:83], v[144:147]
    v_mfma_f32_16x16x32_bf16 v[148:151], a[148:151], v[80:83], v[148:151]
    s_waitcnt lgkmcnt(2)
    v_exp_f32 v75, v75
    v_mfma_f32_16x16x32_bf16 v[152:155], a[152:155], v[80:83], v[152:155]
    s_waitcnt lgkmcnt(0)
    v_cvt_pk_bf16_f32 v85, v74, v75
    v_mfma_f32_16x16x32_bf16 v[156:159], a[156:159], v[80:83], v[156:159]
    v_exp_f32 v76, v76
    v_mfma_f32_16x16x32_bf16 v[64:67], a[64:67], a[32:35], v[56:59]
    v_mfma_f32_16x16x32_bf16 v[64:67], a[68:71], a[36:39], v[64:67]
    v_exp_f32 v77, v77
    v_mfma_f32_16x16x32_bf16 v[64:67], a[72:75], a[40:43], v[64:67]
    buffer_load_dwordx4 v21, s[24:27], 0 offen offset:1024 nt lds
    v_cvt_pk_bf16_f32 v86, v76, v77
    v_mfma_f32_16x16x32_bf16 v[64:67], a[76:79], a[44:47], v[64:67]
    v_exp_f32 v78, v78
    v_mfma_f32_16x16x32_bf16 v[68:71], a[80:83], a[32:35], v[56:59]
    v_mfma_f32_16x16x32_bf16 v[68:71], a[84:87], a[36:39], v[68:71]
    v_exp_f32 v79, v79
    v_mfma_f32_16x16x32_bf16 v[68:71], a[88:91], a[40:43], v[68:71]
    v_cvt_pk_bf16_f32 v87, v78, v79
    v_mfma_f32_16x16x32_bf16 v[68:71], a[92:95], a[44:47], v[68:71]
    s_nop 0
    v_exp_f32 v64, v64
    v_mfma_f32_16x16x32_bf16 v[160:163], a[128:131], v[84:87], v[160:163]
    v_mfma_f32_16x16x32_bf16 v[164:167], a[132:135], v[84:87], v[164:167]
    v_exp_f32 v65, v65
    v_mfma_f32_16x16x32_bf16 v[168:171], a[136:139], v[84:87], v[168:171]
    v_cvt_pk_bf16_f32 v88, v64, v65
    v_mfma_f32_16x16x32_bf16 v[172:175], a[140:143], v[84:87], v[172:175]
    v_exp_f32 v66, v66
    v_smfmac_f32_16x16x64_bf16 v[96:99], v[112:115], v[80:87], v116
    s_waitcnt vmcnt(8)
    v_mfma_f32_16x16x32_bf16 v[176:179], a[144:147], v[84:87], v[176:179]
    s_barrier
    ds_read_b128 a[96:99], v8 offset:40960
    v_mfma_f32_16x16x32_bf16 v[180:183], a[148:151], v[84:87], v[180:183]
    s_add_u32 m0, s15, 8192
    v_exp_f32 v67, v67
    v_mfma_f32_16x16x32_bf16 v[184:187], a[152:155], v[84:87], v[184:187]
    s_xor_b32 s28, s66, 26624
    buffer_load_dwordx4 v22, s[28:31], 0 offen offset:0 nt lds
    v_cvt_pk_bf16_f32 v89, v66, v67
    v_mfma_f32_16x16x32_bf16 v[188:191], a[156:159], v[84:87], v[188:191]
    v_exp_f32 v68, v68
    v_mfma_f32_16x16x32_bf16 v[72:75], a[64:67], a[48:51], v[60:63]
    ds_read_b128 a[100:103], v9 offset:40960
    v_mfma_f32_16x16x32_bf16 v[72:75], a[68:71], a[52:55], v[72:75]
    v_exp_f32 v69, v69
    v_mfma_f32_16x16x32_bf16 v[72:75], a[72:75], a[56:59], v[72:75]
    ds_read_b128 a[104:107], v10 offset:40960
    v_cvt_pk_bf16_f32 v90, v68, v69
    v_mfma_f32_16x16x32_bf16 v[72:75], a[76:79], a[60:63], v[72:75]
    v_exp_f32 v70, v70
    v_mfma_f32_16x16x32_bf16 v[76:79], a[80:83], a[48:51], v[60:63]
    ds_read_b128 a[108:111], v11 offset:40960
    ds_read_b128 a[112:115], v8 offset:45056
    v_mfma_f32_16x16x32_bf16 v[76:79], a[84:87], a[52:55], v[76:79]
    v_exp_f32 v71, v71
    v_mfma_f32_16x16x32_bf16 v[76:79], a[88:91], a[56:59], v[76:79]
    ds_read_b128 a[116:119], v9 offset:45056
    v_cvt_pk_bf16_f32 v91, v70, v71
    v_mfma_f32_16x16x32_bf16 v[76:79], a[92:95], a[60:63], v[76:79]
    v_exp_f32 v72, v72
    v_mfma_f32_16x16x32_bf16 v[192:195], a[128:131], v[88:91], v[192:195]
    ds_read_b128 a[120:123], v10 offset:45056
    ds_read_b128 a[124:127], v11 offset:45056
    v_mfma_f32_16x16x32_bf16 v[196:199], a[132:135], v[88:91], v[196:199]
    v_exp_f32 v73, v73
    v_mfma_f32_16x16x32_bf16 v[200:203], a[136:139], v[88:91], v[200:203]
    buffer_load_dwordx4 v23, s[28:31], 0 offen offset:1024 nt lds
    v_cvt_pk_bf16_f32 v92, v72, v73
    v_mfma_f32_16x16x32_bf16 v[204:207], a[140:143], v[88:91], v[204:207]
    s_waitcnt vmcnt(8)
    v_exp_f32 v74, v74
    v_mfma_f32_16x16x32_bf16 v[208:211], a[144:147], v[88:91], v[208:211]
    s_barrier
    v_mfma_f32_16x16x32_bf16 v[212:215], a[148:151], v[88:91], v[212:215]
    v_exp_f32 v75, v75
    v_mfma_f32_16x16x32_bf16 v[216:219], a[152:155], v[88:91], v[216:219]
    ds_read_b64_tr_b16 a[160:161], v12 offset:40960
    v_cvt_pk_bf16_f32 v93, v74, v75
    v_mfma_f32_16x16x32_bf16 v[220:223], a[156:159], v[88:91], v[220:223]
    s_waitcnt lgkmcnt(3)
    v_exp_f32 v76, v76
    v_mfma_f32_16x16x32_bf16 v[64:67], a[96:99], a[0:3], v[48:51]
    ds_read_b64_tr_b16 a[162:163], v12 offset:45056
    ds_read_b64_tr_b16 a[164:165], v13 offset:40960
    v_mfma_f32_16x16x32_bf16 v[64:67], a[100:103], a[4:7], v[64:67]
    v_exp_f32 v77, v77
    v_mfma_f32_16x16x32_bf16 v[64:67], a[104:107], a[8:11], v[64:67]
    ds_read_b64_tr_b16 a[166:167], v13 offset:45056
    v_cvt_pk_bf16_f32 v94, v76, v77
    v_mfma_f32_16x16x32_bf16 v[64:67], a[108:111], a[12:15], v[64:67]
    v_exp_f32 v78, v78
    v_mfma_f32_16x16x32_bf16 v[68:71], a[112:115], a[0:3], v[48:51]
    ds_read_b64_tr_b16 a[168:169], v14 offset:40960
    v_mfma_f32_16x16x32_bf16 v[68:71], a[116:119], a[4:7], v[68:71]
    s_waitcnt lgkmcnt(5)
    s_add_u32 m0, s14, 16384
    v_exp_f32 v79, v79
    v_mfma_f32_16x16x32_bf16 v[68:71], a[120:123], a[8:11], v[68:71]
    s_xor_b32 s24, s65, 28672
    buffer_load_dwordx4 v20, s[24:27], 0 offen offset:0 nt lds
    v_cvt_pk_bf16_f32 v95, v78, v79
    v_mfma_f32_16x16x32_bf16 v[68:71], a[124:127], a[12:15], v[68:71]
    v_exp_f32 v64, v64
    v_mfma_f32_16x16x32_bf16 v[224:227], a[128:131], v[92:95], v[224:227]
    ds_read_b64_tr_b16 a[170:171], v14 offset:45056
    ds_read_b64_tr_b16 a[172:173], v15 offset:40960
    v_mfma_f32_16x16x32_bf16 v[228:231], a[132:135], v[92:95], v[228:231]
    v_exp_f32 v65, v65
    v_mfma_f32_16x16x32_bf16 v[232:235], a[136:139], v[92:95], v[232:235]
    ds_read_b64_tr_b16 a[174:175], v15 offset:45056
    v_cvt_pk_bf16_f32 v80, v64, v65
    v_mfma_f32_16x16x32_bf16 v[236:239], a[140:143], v[92:95], v[236:239]
    v_exp_f32 v66, v66
    v_smfmac_f32_16x16x64_bf16 v[100:103], v[112:115], v[88:95], v116
    ds_read_b64_tr_b16 a[176:177], v16 offset:40960
    v_mfma_f32_16x16x32_bf16 v[240:243], a[144:147], v[92:95], v[240:243]
    ds_read_b64_tr_b16 a[178:179], v16 offset:45056
    ds_read_b64_tr_b16 a[180:181], v17 offset:40960
    v_mfma_f32_16x16x32_bf16 v[244:247], a[148:151], v[92:95], v[244:247]
    v_exp_f32 v67, v67
    v_mfma_f32_16x16x32_bf16 v[248:251], a[152:155], v[92:95], v[248:251]
    ds_read_b64_tr_b16 a[182:183], v17 offset:45056
    v_cvt_pk_bf16_f32 v81, v66, v67
    v_mfma_f32_16x16x32_bf16 v[252:255], a[156:159], v[92:95], v[252:255]
    v_exp_f32 v68, v68
    v_mfma_f32_16x16x32_bf16 v[72:75], a[96:99], a[16:19], v[52:55]
    ds_read_b64_tr_b16 a[184:185], v18 offset:40960
    v_mfma_f32_16x16x32_bf16 v[72:75], a[100:103], a[20:23], v[72:75]
    v_exp_f32 v69, v69
    v_mfma_f32_16x16x32_bf16 v[72:75], a[104:107], a[24:27], v[72:75]
    buffer_load_dwordx4 v21, s[24:27], 0 offen offset:1024 nt lds
    v_cvt_pk_bf16_f32 v82, v68, v69
    v_mfma_f32_16x16x32_bf16 v[72:75], a[108:111], a[28:31], v[72:75]
    v_exp_f32 v70, v70
    v_mfma_f32_16x16x32_bf16 v[76:79], a[112:115], a[16:19], v[52:55]
    ds_read_b64_tr_b16 a[186:187], v18 offset:45056
    ds_read_b64_tr_b16 a[188:189], v19 offset:40960
    v_mfma_f32_16x16x32_bf16 v[76:79], a[116:119], a[20:23], v[76:79]
    v_exp_f32 v71, v71
    v_mfma_f32_16x16x32_bf16 v[76:79], a[120:123], a[24:27], v[76:79]
    ds_read_b64_tr_b16 a[190:191], v19 offset:45056
    v_cvt_pk_bf16_f32 v83, v70, v71
    v_mfma_f32_16x16x32_bf16 v[76:79], a[124:127], a[28:31], v[76:79]
    s_waitcnt lgkmcnt(4)
    v_exp_f32 v72, v72
    v_mfma_f32_16x16x32_bf16 v[128:131], a[160:163], v[80:83], v[128:131]
    v_mfma_f32_16x16x32_bf16 v[132:135], a[164:167], v[80:83], v[132:135]
    v_exp_f32 v73, v73
    v_mfma_f32_16x16x32_bf16 v[136:139], a[168:171], v[80:83], v[136:139]
    v_cvt_pk_bf16_f32 v84, v72, v73
    v_mfma_f32_16x16x32_bf16 v[140:143], a[172:175], v[80:83], v[140:143]
    v_exp_f32 v74, v74
    v_mfma_f32_16x16x32_bf16 v[144:147], a[176:179], v[80:83], v[144:147]
    v_mfma_f32_16x16x32_bf16 v[148:151], a[180:183], v[80:83], v[148:151]
    s_waitcnt lgkmcnt(2)
    s_add_u32 m0, s15, 16384
    v_exp_f32 v75, v75
    v_mfma_f32_16x16x32_bf16 v[152:155], a[184:187], v[80:83], v[152:155]
    s_waitcnt lgkmcnt(0)
    s_xor_b32 s28, s66, 28672
    buffer_load_dwordx4 v22, s[28:31], 0 offen offset:0 nt lds
    v_cvt_pk_bf16_f32 v85, v74, v75
    v_mfma_f32_16x16x32_bf16 v[156:159], a[188:191], v[80:83], v[156:159]
    v_exp_f32 v76, v76
    v_mfma_f32_16x16x32_bf16 v[64:67], a[96:99], a[32:35], v[56:59]
    v_mfma_f32_16x16x32_bf16 v[64:67], a[100:103], a[36:39], v[64:67]
    v_exp_f32 v77, v77
    v_mfma_f32_16x16x32_bf16 v[64:67], a[104:107], a[40:43], v[64:67]
    v_cvt_pk_bf16_f32 v86, v76, v77
    v_mfma_f32_16x16x32_bf16 v[64:67], a[108:111], a[44:47], v[64:67]
    v_exp_f32 v78, v78
    v_mfma_f32_16x16x32_bf16 v[68:71], a[112:115], a[32:35], v[56:59]
    v_mfma_f32_16x16x32_bf16 v[68:71], a[116:119], a[36:39], v[68:71]
    v_exp_f32 v79, v79
    v_mfma_f32_16x16x32_bf16 v[68:71], a[120:123], a[40:43], v[68:71]
    v_cvt_pk_bf16_f32 v87, v78, v79
    v_mfma_f32_16x16x32_bf16 v[68:71], a[124:127], a[44:47], v[68:71]
    s_nop 0
    v_exp_f32 v64, v64
    v_mfma_f32_16x16x32_bf16 v[160:163], a[160:163], v[84:87], v[160:163]
    v_mfma_f32_16x16x32_bf16 v[164:167], a[164:167], v[84:87], v[164:167]
    v_exp_f32 v65, v65
    v_mfma_f32_16x16x32_bf16 v[168:171], a[168:171], v[84:87], v[168:171]
    v_cvt_pk_bf16_f32 v88, v64, v65
    v_mfma_f32_16x16x32_bf16 v[172:175], a[172:175], v[84:87], v[172:175]
    v_exp_f32 v66, v66
    v_smfmac_f32_16x16x64_bf16 v[96:99], v[112:115], v[80:87], v116
    s_waitcnt vmcnt(9)
    buffer_load_dwordx4 v23, s[28:31], 0 offen offset:1024 nt lds
    v_mfma_f32_16x16x32_bf16 v[176:179], a[176:179], v[84:87], v[176:179]
    s_barrier
    v_mfma_f32_16x16x32_bf16 v[180:183], a[180:183], v[84:87], v[180:183]
    v_exp_f32 v67, v67
    v_mfma_f32_16x16x32_bf16 v[184:187], a[184:187], v[84:87], v[184:187]
    ds_read_b128 a[64:67], v8 offset:0
    v_cvt_pk_bf16_f32 v89, v66, v67
    v_mfma_f32_16x16x32_bf16 v[188:191], a[188:191], v[84:87], v[188:191]
    v_exp_f32 v68, v68
    v_mfma_f32_16x16x32_bf16 v[72:75], a[96:99], a[48:51], v[60:63]
    ds_read_b128 a[68:71], v9 offset:0
    ds_read_b128 a[72:75], v10 offset:0
    v_mfma_f32_16x16x32_bf16 v[72:75], a[100:103], a[52:55], v[72:75]
    v_exp_f32 v69, v69
    v_mfma_f32_16x16x32_bf16 v[72:75], a[104:107], a[56:59], v[72:75]
    ds_read_b128 a[76:79], v11 offset:0
    v_cvt_pk_bf16_f32 v90, v68, v69
    v_mfma_f32_16x16x32_bf16 v[72:75], a[108:111], a[60:63], v[72:75]
    v_exp_f32 v70, v70
    v_mfma_f32_16x16x32_bf16 v[76:79], a[112:115], a[48:51], v[60:63]
    ds_read_b128 a[80:83], v8 offset:4096
    v_mfma_f32_16x16x32_bf16 v[76:79], a[116:119], a[52:55], v[76:79]
    v_exp_f32 v71, v71
    v_mfma_f32_16x16x32_bf16 v[76:79], a[120:123], a[56:59], v[76:79]
    ds_read_b128 a[84:87], v9 offset:4096
    v_cvt_pk_bf16_f32 v91, v70, v71
    v_mfma_f32_16x16x32_bf16 v[76:79], a[124:127], a[60:63], v[76:79]
    s_add_u32 m0, s14, 24576
    v_exp_f32 v72, v72
    v_mfma_f32_16x16x32_bf16 v[192:195], a[160:163], v[88:91], v[192:195]
    s_xor_b32 s24, s65, 30720
    buffer_load_dwordx4 v20, s[24:27], 0 offen offset:0 nt lds
    ds_read_b128 a[88:91], v10 offset:4096
    v_mfma_f32_16x16x32_bf16 v[196:199], a[164:167], v[88:91], v[196:199]
    v_exp_f32 v73, v73
    v_mfma_f32_16x16x32_bf16 v[200:203], a[168:171], v[88:91], v[200:203]
    ds_read_b128 a[92:95], v11 offset:4096
    v_cvt_pk_bf16_f32 v92, v72, v73
    v_mfma_f32_16x16x32_bf16 v[204:207], a[172:175], v[88:91], v[204:207]
    s_waitcnt vmcnt(9)
    v_exp_f32 v74, v74
    v_mfma_f32_16x16x32_bf16 v[208:211], a[176:179], v[88:91], v[208:211]
    s_barrier
    v_mfma_f32_16x16x32_bf16 v[212:215], a[180:183], v[88:91], v[212:215]
    v_exp_f32 v75, v75
    v_mfma_f32_16x16x32_bf16 v[216:219], a[184:187], v[88:91], v[216:219]
    ds_read_b64_tr_b16 a[128:129], v12 offset:0
    v_cvt_pk_bf16_f32 v93, v74, v75
    v_mfma_f32_16x16x32_bf16 v[220:223], a[188:191], v[88:91], v[220:223]
    s_waitcnt lgkmcnt(3)
    v_exp_f32 v76, v76
    v_mfma_f32_16x16x32_bf16 v[64:67], a[64:67], a[0:3], v[48:51]
    ds_read_b64_tr_b16 a[130:131], v12 offset:4096
    ds_read_b64_tr_b16 a[132:133], v13 offset:0
    v_mfma_f32_16x16x32_bf16 v[64:67], a[68:71], a[4:7], v[64:67]
    v_exp_f32 v77, v77
    v_mfma_f32_16x16x32_bf16 v[64:67], a[72:75], a[8:11], v[64:67]
    ds_read_b64_tr_b16 a[134:135], v13 offset:4096
    v_cvt_pk_bf16_f32 v94, v76, v77
    v_mfma_f32_16x16x32_bf16 v[64:67], a[76:79], a[12:15], v[64:67]
    v_exp_f32 v78, v78
    v_mfma_f32_16x16x32_bf16 v[68:71], a[80:83], a[0:3], v[48:51]
    buffer_load_dwordx4 v21, s[24:27], 0 offen offset:1024 nt lds
    ds_read_b64_tr_b16 a[136:137], v14 offset:0
    v_mfma_f32_16x16x32_bf16 v[68:71], a[84:87], a[4:7], v[68:71]
    s_waitcnt lgkmcnt(5)
    v_exp_f32 v79, v79
    v_mfma_f32_16x16x32_bf16 v[68:71], a[88:91], a[8:11], v[68:71]
    ds_read_b64_tr_b16 a[138:139], v14 offset:4096
    v_cvt_pk_bf16_f32 v95, v78, v79
    v_mfma_f32_16x16x32_bf16 v[68:71], a[92:95], a[12:15], v[68:71]
    v_exp_f32 v64, v64
    v_mfma_f32_16x16x32_bf16 v[224:227], a[160:163], v[92:95], v[224:227]
    ds_read_b64_tr_b16 a[140:141], v15 offset:0
    v_mfma_f32_16x16x32_bf16 v[228:231], a[164:167], v[92:95], v[228:231]
    v_exp_f32 v65, v65
    v_mfma_f32_16x16x32_bf16 v[232:235], a[168:171], v[92:95], v[232:235]
    ds_read_b64_tr_b16 a[142:143], v15 offset:4096
    v_cvt_pk_bf16_f32 v80, v64, v65
    v_mfma_f32_16x16x32_bf16 v[236:239], a[172:175], v[92:95], v[236:239]
    v_exp_f32 v66, v66
    v_smfmac_f32_16x16x64_bf16 v[100:103], v[112:115], v[88:95], v116
    ds_read_b64_tr_b16 a[144:145], v16 offset:0
    v_mfma_f32_16x16x32_bf16 v[240:243], a[176:179], v[92:95], v[240:243]
    ds_read_b64_tr_b16 a[146:147], v16 offset:4096
    ds_read_b64_tr_b16 a[148:149], v17 offset:0
    v_mfma_f32_16x16x32_bf16 v[244:247], a[180:183], v[92:95], v[244:247]
    v_exp_f32 v67, v67
    v_mfma_f32_16x16x32_bf16 v[248:251], a[184:187], v[92:95], v[248:251]
    ds_read_b64_tr_b16 a[150:151], v17 offset:4096
    v_cvt_pk_bf16_f32 v81, v66, v67
    v_mfma_f32_16x16x32_bf16 v[252:255], a[188:191], v[92:95], v[252:255]
    s_add_u32 m0, s15, 24576
    v_exp_f32 v68, v68
    v_mfma_f32_16x16x32_bf16 v[72:75], a[64:67], a[16:19], v[52:55]
    s_xor_b32 s28, s66, 30720
    buffer_load_dwordx4 v22, s[28:31], 0 offen offset:0 nt lds
    ds_read_b64_tr_b16 a[152:153], v18 offset:0
    v_mfma_f32_16x16x32_bf16 v[72:75], a[68:71], a[20:23], v[72:75]
    v_exp_f32 v69, v69
    v_mfma_f32_16x16x32_bf16 v[72:75], a[72:75], a[24:27], v[72:75]
    ds_read_b64_tr_b16 a[154:155], v18 offset:4096
    v_cvt_pk_bf16_f32 v82, v68, v69
    v_mfma_f32_16x16x32_bf16 v[72:75], a[76:79], a[28:31], v[72:75]
    v_exp_f32 v70, v70
    v_mfma_f32_16x16x32_bf16 v[76:79], a[80:83], a[16:19], v[52:55]
    ds_read_b64_tr_b16 a[156:157], v19 offset:0
    v_mfma_f32_16x16x32_bf16 v[76:79], a[84:87], a[20:23], v[76:79]
L_hop3:
    s_cbranch_execz L_hop_back
    v_exp_f32 v71, v71
    v_mfma_f32_16x16x32_bf16 v[76:79], a[88:91], a[24:27], v[76:79]
    ds_read_b64_tr_b16 a[158:159], v19 offset:4096
    v_cvt_pk_bf16_f32 v83, v70, v71
    v_mfma_f32_16x16x32_bf16 v[76:79], a[92:95], a[28:31], v[76:79]
    s_waitcnt lgkmcnt(4)
    v_exp_f32 v72, v72
    v_mfma_f32_16x16x32_bf16 v[128:131], a[128:131], v[80:83], v[128:131]
    v_mfma_f32_16x16x32_bf16 v[132:135], a[132:135], v[80:83], v[132:135]
    v_exp_f32 v73, v73
    v_mfma_f32_16x16x32_bf16 v[136:139], a[136:139], v[80:83], v[136:139]
    v_cvt_pk_bf16_f32 v84, v72, v73
    v_mfma_f32_16x16x32_bf16 v[140:143], a[140:143], v[80:83], v[140:143]
    v_exp_f32 v74, v74
    v_mfma_f32_16x16x32_bf16 v[144:147], a[144:147], v[80:83], v[144:147]
    buffer_load_dwordx4 v23, s[28:31], 0 offen offset:1024 nt lds
    v_mfma_f32_16x16x32_bf16 v[148:151], a[148:151], v[80:83], v[148:151]
    s_waitcnt lgkmcnt(2)
    v_exp_f32 v75, v75
    v_mfma_f32_16x16x32_bf16 v[152:155], a[152:155], v[80:83], v[152:155]
    s_waitcnt lgkmcnt(0)
    v_cvt_pk_bf16_f32 v85, v74, v75
    v_mfma_f32_16x16x32_bf16 v[156:159], a[156:159], v[80:83], v[156:159]
    v_exp_f32 v76, v76
    v_mfma_f32_16x16x32_bf16 v[64:67], a[64:67], a[32:35], v[56:59]
    v_mfma_f32_16x16x32_bf16 v[64:67], a[68:71], a[36:39], v[64:67]
    v_exp_f32 v77, v77
    v_mfma_f32_16x16x32_bf16 v[64:67], a[72:75], a[40:43], v[64:67]
    v_cvt_pk_bf16_f32 v86, v76, v77
    v_mfma_f32_16x16x32_bf16 v[64:67], a[76:79], a[44:47], v[64:67]
    v_exp_f32 v78, v78
    v_mfma_f32_16x16x32_bf16 v[68:71], a[80:83], a[32:35], v[56:59]
    v_mfma_f32_16x16x32_bf16 v[68:71], a[84:87], a[36:39], v[68:71]
    v_exp_f32 v79, v79
    v_mfma_f32_16x16x32_bf16 v[68:71], a[88:91], a[40:43], v[68:71]
    v_cvt_pk_bf16_f32 v87, v78, v79
    v_mfma_f32_16x16x32_bf16 v[68:71], a[92:95], a[44:47], v[68:71]
    s_nop 0
    v_exp_f32 v64, v64
    v_mfma_f32_16x16x32_bf16 v[160:163], a[128:131], v[84:87], v[160:163]
    v_mfma_f32_16x16x32_bf16 v[164:167], a[132:135], v[84:87], v[164:167]
    v_exp_f32 v65, v65
    v_mfma_f32_16x16x32_bf16 v[168:171], a[136:139], v[84:87], v[168:171]
    v_cvt_pk_bf16_f32 v88, v64, v65
    v_mfma_f32_16x16x32_bf16 v[172:175], a[140:143], v[84:87], v[172:175]
    v_exp_f32 v66, v66
    v_smfmac_f32_16x16x64_bf16 v[96:99], v[112:115], v[80:87], v116
    s_waitcnt vmcnt(10)
    v_mfma_f32_16x16x32_bf16 v[176:179], a[144:147], v[84:87], v[176:179]
    s_barrier
    v_mfma_f32_16x16x32_bf16 v[180:183], a[148:151], v[84:87], v[180:183]
    v_exp_f32 v67, v67
    v_mfma_f32_16x16x32_bf16 v[184:187], a[152:155], v[84:87], v[184:187]
    ds_read_b128 a[96:99], v8 offset:8192
    v_cvt_pk_bf16_f32 v89, v66, v67
    v_mfma_f32_16x16x32_bf16 v[188:191], a[156:159], v[84:87], v[188:191]
    v_exp_f32 v68, v68
    v_mfma_f32_16x16x32_bf16 v[72:75], a[64:67], a[48:51], v[60:63]
    ds_read_b128 a[100:103], v9 offset:8192
    v_mfma_f32_16x16x32_bf16 v[72:75], a[68:71], a[52:55], v[72:75]
    v_exp_f32 v69, v69
    v_mfma_f32_16x16x32_bf16 v[72:75], a[72:75], a[56:59], v[72:75]
    ds_read_b128 a[104:107], v10 offset:8192
    v_cvt_pk_bf16_f32 v90, v68, v69
    v_mfma_f32_16x16x32_bf16 v[72:75], a[76:79], a[60:63], v[72:75]
    v_exp_f32 v70, v70
    v_mfma_f32_16x16x32_bf16 v[76:79], a[80:83], a[48:51], v[60:63]
    ds_read_b128 a[108:111], v11 offset:8192
    ds_read_b128 a[112:115], v8 offset:12288
    v_mfma_f32_16x16x32_bf16 v[76:79], a[84:87], a[52:55], v[76:79]
    v_exp_f32 v71, v71
    v_mfma_f32_16x16x32_bf16 v[76:79], a[88:91], a[56:59], v[76:79]
    ds_read_b128 a[116:119], v9 offset:12288
    v_cvt_pk_bf16_f32 v91, v70, v71
    v_mfma_f32_16x16x32_bf16 v[76:79], a[92:95], a[60:63], v[76:79]
    v_exp_f32 v72, v72
    v_mfma_f32_16x16x32_bf16 v[192:195], a[128:131], v[88:91], v[192:195]
    ds_read_b128 a[120:123], v10 offset:12288
    v_mfma_f32_16x16x32_bf16 v[196:199], a[132:135], v[88:91], v[196:199]
    v_exp_f32 v73, v73
    v_mfma_f32_16x16x32_bf16 v[200:203], a[136:139], v[88:91], v[200:203]
    ds_read_b128 a[124:127], v11 offset:12288
    v_cvt_pk_bf16_f32 v92, v72, v73
    v_mfma_f32_16x16x32_bf16 v[204:207], a[140:143], v[88:91], v[204:207]
    s_waitcnt vmcnt(8)
    v_exp_f32 v74, v74
    v_mfma_f32_16x16x32_bf16 v[208:211], a[144:147], v[88:91], v[208:211]
    s_barrier
    v_mfma_f32_16x16x32_bf16 v[212:215], a[148:151], v[88:91], v[212:215]
    v_exp_f32 v75, v75
    v_mfma_f32_16x16x32_bf16 v[216:219], a[152:155], v[88:91], v[216:219]
    ds_read_b64_tr_b16 a[160:161], v12 offset:8192
    v_cvt_pk_bf16_f32 v93, v74, v75
    v_mfma_f32_16x16x32_bf16 v[220:223], a[156:159], v[88:91], v[220:223]
    s_waitcnt lgkmcnt(3)
    v_exp_f32 v76, v76
    v_mfma_f32_16x16x32_bf16 v[64:67], a[96:99], a[0:3], v[48:51]
    ds_read_b64_tr_b16 a[162:163], v12 offset:12288
    v_mfma_f32_16x16x32_bf16 v[64:67], a[100:103], a[4:7], v[64:67]
    v_exp_f32 v77, v77
    v_mfma_f32_16x16x32_bf16 v[64:67], a[104:107], a[8:11], v[64:67]
    ds_read_b64_tr_b16 a[164:165], v13 offset:8192
    v_cvt_pk_bf16_f32 v94, v76, v77
    v_mfma_f32_16x16x32_bf16 v[64:67], a[108:111], a[12:15], v[64:67]
    v_exp_f32 v78, v78
    v_mfma_f32_16x16x32_bf16 v[68:71], a[112:115], a[0:3], v[48:51]
    ds_read_b64_tr_b16 a[166:167], v13 offset:12288
    ds_read_b64_tr_b16 a[168:169], v14 offset:8192
    v_mfma_f32_16x16x32_bf16 v[68:71], a[116:119], a[4:7], v[68:71]
    s_waitcnt lgkmcnt(5)
    v_exp_f32 v79, v79
    v_mfma_f32_16x16x32_bf16 v[68:71], a[120:123], a[8:11], v[68:71]
    ds_read_b64_tr_b16 a[170:171], v14 offset:12288
    v_cvt_pk_bf16_f32 v95, v78, v79
    v_mfma_f32_16x16x32_bf16 v[68:71], a[124:127], a[12:15], v[68:71]
    v_exp_f32 v64, v64
    v_mfma_f32_16x16x32_bf16 v[224:227], a[128:131], v[92:95], v[224:227]
    ds_read_b64_tr_b16 a[172:173], v15 offset:8192
    v_mfma_f32_16x16x32_bf16 v[228:231], a[132:135], v[92:95], v[228:231]
    v_exp_f32 v65, v65
    v_mfma_f32_16x16x32_bf16 v[232:235], a[136:139], v[92:95], v[232:235]
    ds_read_b64_tr_b16 a[174:175], v15 offset:12288
    v_cvt_pk_bf16_f32 v80, v64, v65
    v_mfma_f32_16x16x32_bf16 v[236:239], a[140:143], v[92:95], v[236:239]
    v_exp_f32 v66, v66
    v_smfmac_f32_16x16x64_bf16 v[100:103], v[112:115], v[88:95], v116
    ds_read_b64_tr_b16 a[176:177], v16 offset:8192
    v_mfma_f32_16x16x32_bf16 v[240:243], a[144:147], v[92:95], v[240:243]
    ds_read_b64_tr_b16 a[178:179], v16 offset:12288
    v_mfma_f32_16x16x32_bf16 v[244:247], a[148:151], v[92:95], v[244:247]
    v_exp_f32 v67, v67
    v_mfma_f32_16x16x32_bf16 v[248:251], a[152:155], v[92:95], v[248:251]
    ds_read_b64_tr_b16 a[180:181], v17 offset:8192
    v_cvt_pk_bf16_f32 v81, v66, v67
    v_mfma_f32_16x16x32_bf16 v[252:255], a[156:159], v[92:95], v[252:255]
    v_exp_f32 v68, v68
    v_mfma_f32_16x16x32_bf16 v[72:75], a[96:99], a[16:19], v[52:55]
    ds_read_b64_tr_b16 a[182:183], v17 offset:12288
    ds_read_b64_tr_b16 a[184:185], v18 offset:8192
    v_mfma_f32_16x16x32_bf16 v[72:75], a[100:103], a[20:23], v[72:75]
    v_exp_f32 v69, v69
    v_mfma_f32_16x16x32_bf16 v[72:75], a[104:107], a[24:27], v[72:75]
    ds_read_b64_tr_b16 a[186:187], v18 offset:12288
    v_cvt_pk_bf16_f32 v82, v68, v69
    v_mfma_f32_16x16x32_bf16 v[72:75], a[108:111], a[28:31], v[72:75]
    v_exp_f32 v70, v70
    v_mfma_f32_16x16x32_bf16 v[76:79], a[112:115], a[16:19], v[52:55]
    ds_read_b64_tr_b16 a[188:189], v19 offset:8192
    v_mfma_f32_16x16x32_bf16 v[76:79], a[116:119], a[20:23], v[76:79]
    v_exp_f32 v71, v71
    v_mfma_f32_16x16x32_bf16 v[76:79], a[120:123], a[24:27], v[76:79]
    ds_read_b64_tr_b16 a[190:191], v19 offset:12288
    v_cvt_pk_bf16_f32 v83, v70, v71
    v_mfma_f32_16x16x32_bf16 v[76:79], a[124:127], a[28:31], v[76:79]
    s_waitcnt lgkmcnt(5)
    v_exp_f32 v72, v72
    v_mfma_f32_16x16x32_bf16 v[128:131], a[160:163], v[80:83], v[128:131]
    v_mfma_f32_16x16x32_bf16 v[132:135], a[164:167], v[80:83], v[132:135]
    v_exp_f32 v73, v73
    v_mfma_f32_16x16x32_bf16 v[136:139], a[168:171], v[80:83], v[136:139]
    v_cvt_pk_bf16_f32 v84, v72, v73
    v_mfma_f32_16x16x32_bf16 v[140:143], a[172:175], v[80:83], v[140:143]
    v_exp_f32 v74, v74
    v_mfma_f32_16x16x32_bf16 v[144:147], a[176:179], v[80:83], v[144:147]
    s_waitcnt lgkmcnt(3)
    v_mfma_f32_16x16x32_bf16 v[148:151], a[180:183], v[80:83], v[148:151]
    s_waitcnt lgkmcnt(2)
    v_exp_f32 v75, v75
    v_mfma_f32_16x16x32_bf16 v[152:155], a[184:187], v[80:83], v[152:155]
    s_waitcnt lgkmcnt(0)
    v_cvt_pk_bf16_f32 v85, v74, v75
    v_mfma_f32_16x16x32_bf16 v[156:159], a[188:191], v[80:83], v[156:159]
    v_exp_f32 v76, v76
    v_mfma_f32_16x16x32_bf16 v[64:67], a[96:99], a[32:35], v[56:59]
    v_mfma_f32_16x16x32_bf16 v[64:67], a[100:103], a[36:39], v[64:67]
    v_exp_f32 v77, v77
    v_mfma_f32_16x16x32_bf16 v[64:67], a[104:107], a[40:43], v[64:67]
    v_cvt_pk_bf16_f32 v86, v76, v77
    v_mfma_f32_16x16x32_bf16 v[64:67], a[108:111], a[44:47], v[64:67]
    s_waitcnt vmcnt(6)
    v_exp_f32 v78, v78
    v_mfma_f32_16x16x32_bf16 v[68:71], a[112:115], a[32:35], v[56:59]
    s_barrier
    v_mfma_f32_16x16x32_bf16 v[68:71], a[116:119], a[36:39], v[68:71]
    v_exp_f32 v79, v79
    v_mfma_f32_16x16x32_bf16 v[68:71], a[120:123], a[40:43], v[68:71]
    ds_read_b128 a[64:67], v8 offset:16384
    v_cvt_pk_bf16_f32 v87, v78, v79
    v_mfma_f32_16x16x32_bf16 v[68:71], a[124:127], a[44:47], v[68:71]
    v_exp_f32 v64, v64
    v_mfma_f32_16x16x32_bf16 v[160:163], a[160:163], v[84:87], v[160:163]
    ds_read_b128 a[68:71], v9 offset:16384
    ds_read_b128 a[72:75], v10 offset:16384
    v_mfma_f32_16x16x32_bf16 v[164:167], a[164:167], v[84:87], v[164:167]
    v_exp_f32 v65, v65
    v_mfma_f32_16x16x32_bf16 v[168:171], a[168:171], v[84:87], v[168:171]
    ds_read_b128 a[76:79], v11 offset:16384
    v_cvt_pk_bf16_f32 v88, v64, v65
    v_mfma_f32_16x16x32_bf16 v[172:175], a[172:175], v[84:87], v[172:175]
    v_exp_f32 v66, v66
    v_smfmac_f32_16x16x64_bf16 v[96:99], v[112:115], v[80:87], v116
    ds_read_b128 a[80:83], v8 offset:20480
    v_mfma_f32_16x16x32_bf16 v[176:179], a[176:179], v[84:87], v[176:179]
    ds_read_b128 a[84:87], v9 offset:20480
    ds_read_b128 a[88:91], v10 offset:20480
    v_mfma_f32_16x16x32_bf16 v[180:183], a[180:183], v[84:87], v[180:183]
    v_exp_f32 v67, v67
    v_mfma_f32_16x16x32_bf16 v[184:187], a[184:187], v[84:87], v[184:187]
    ds_read_b128 a[92:95], v11 offset:20480
    v_cvt_pk_bf16_f32 v89, v66, v67
    v_mfma_f32_16x16x32_bf16 v[188:191], a[188:191], v[84:87], v[188:191]
    s_waitcnt vmcnt(4)
    v_exp_f32 v68, v68
    v_mfma_f32_16x16x32_bf16 v[72:75], a[96:99], a[48:51], v[60:63]
    s_barrier
    ds_read_b64_tr_b16 a[128:129], v12 offset:16384
    v_mfma_f32_16x16x32_bf16 v[72:75], a[100:103], a[52:55], v[72:75]
    v_exp_f32 v69, v69
    v_mfma_f32_16x16x32_bf16 v[72:75], a[104:107], a[56:59], v[72:75]
    ds_read_b64_tr_b16 a[130:131], v12 offset:20480
    v_cvt_pk_bf16_f32 v90, v68, v69
    v_mfma_f32_16x16x32_bf16 v[72:75], a[108:111], a[60:63], v[72:75]
    v_exp_f32 v70, v70
    v_mfma_f32_16x16x32_bf16 v[76:79], a[112:115], a[48:51], v[60:63]
    ds_read_b64_tr_b16 a[132:133], v13 offset:16384
    v_mfma_f32_16x16x32_bf16 v[76:79], a[116:119], a[52:55], v[76:79]
    v_exp_f32 v71, v71
    v_mfma_f32_16x16x32_bf16 v[76:79], a[120:123], a[56:59], v[76:79]
    ds_read_b64_tr_b16 a[134:135], v13 offset:20480
    v_cvt_pk_bf16_f32 v91, v70, v71
    v_mfma_f32_16x16x32_bf16 v[76:79], a[124:127], a[60:63], v[76:79]
    v_exp_f32 v72, v72
    v_mfma_f32_16x16x32_bf16 v[192:195], a[160:163], v[88:91], v[192:195]
    ds_read_b64_tr_b16 a[136:137], v14 offset:16384
    ds_read_b64_tr_b16 a[138:139], v14 offset:20480
    v_mfma_f32_16x16x32_bf16 v[196:199], a[164:167], v[88:91], v[196:199]
    s_waitcnt vmcnt(2)
    v_exp_f32 v73, v73
    v_mfma_f32_16x16x32_bf16 v[200:203], a[168:171], v[88:91], v[200:203]
    s_barrier
    v_cvt_pk_bf16_f32 v92, v72, v73
    v_mfma_f32_16x16x32_bf16 v[204:207], a[172:175], v[88:91], v[204:207]
    v_exp_f32 v74, v74
    v_mfma_f32_16x16x32_bf16 v[208:211], a[176:179], v[88:91], v[208:211]
    ds_read_b128 a[96:99], v8 offset:24576
    ds_read_b64_tr_b16 a[140:141], v15 offset:16384
    v_mfma_f32_16x16x32_bf16 v[212:215], a[180:183], v[88:91], v[212:215]
    v_exp_f32 v75, v75
    v_mfma_f32_16x16x32_bf16 v[216:219], a[184:187], v[88:91], v[216:219]
    ds_read_b128 a[100:103], v9 offset:24576
    v_cvt_pk_bf16_f32 v93, v74, v75
    v_mfma_f32_16x16x32_bf16 v[220:223], a[188:191], v[88:91], v[220:223]
    s_waitcnt lgkmcnt(5)
    v_exp_f32 v76, v76
    v_mfma_f32_16x16x32_bf16 v[64:67], a[64:67], a[0:3], v[48:51]
    ds_read_b64_tr_b16 a[142:143], v15 offset:20480
    ds_read_b128 a[104:107], v10 offset:24576
    v_mfma_f32_16x16x32_bf16 v[64:67], a[68:71], a[4:7], v[64:67]
    v_exp_f32 v77, v77
    v_mfma_f32_16x16x32_bf16 v[64:67], a[72:75], a[8:11], v[64:67]
    ds_read_b64_tr_b16 a[144:145], v16 offset:16384
    v_cvt_pk_bf16_f32 v94, v76, v77
    v_mfma_f32_16x16x32_bf16 v[64:67], a[76:79], a[12:15], v[64:67]
    v_exp_f32 v78, v78
    v_mfma_f32_16x16x32_bf16 v[68:71], a[80:83], a[0:3], v[48:51]
    ds_read_b128 a[108:111], v11 offset:24576
    ds_read_b64_tr_b16 a[146:147], v16 offset:20480
    v_mfma_f32_16x16x32_bf16 v[68:71], a[84:87], a[4:7], v[68:71]
    v_exp_f32 v79, v79
    v_mfma_f32_16x16x32_bf16 v[68:71], a[88:91], a[8:11], v[68:71]
    ds_read_b128 a[112:115], v8 offset:28672
    v_cvt_pk_bf16_f32 v95, v78, v79
    v_mfma_f32_16x16x32_bf16 v[68:71], a[92:95], a[12:15], v[68:71]
    v_exp_f32 v64, v64
    v_mfma_f32_16x16x32_bf16 v[224:227], a[160:163], v[92:95], v[224:227]
    ds_read_b64_tr_b16 a[148:149], v17 offset:16384
    ds_read_b128 a[116:119], v9 offset:28672
    v_mfma_f32_16x16x32_bf16 v[228:231], a[164:167], v[92:95], v[228:231]
    v_exp_f32 v65, v65
    v_mfma_f32_16x16x32_bf16 v[232:235], a[168:171], v[92:95], v[232:235]
    ds_read_b64_tr_b16 a[150:151], v17 offset:20480
    v_cvt_pk_bf16_f32 v80, v64, v65
    v_mfma_f32_16x16x32_bf16 v[236:239], a[172:175], v[92:95], v[236:239]
    v_exp_f32 v66, v66
    v_smfmac_f32_16x16x64_bf16 v[100:103], v[112:115], v[88:95], v116
    ds_read_b128 a[120:123], v10 offset:28672
    ds_read_b64_tr_b16 a[152:153], v18 offset:16384
    v_mfma_f32_16x16x32_bf16 v[240:243], a[176:179], v[92:95], v[240:243]
    ds_read_b128 a[124:127], v11 offset:28672
    ds_read_b64_tr_b16 a[154:155], v18 offset:20480
    v_mfma_f32_16x16x32_bf16 v[244:247], a[180:183], v[92:95], v[244:247]
    v_exp_f32 v67, v67
    v_mfma_f32_16x16x32_bf16 v[248:251], a[184:187], v[92:95], v[248:251]
    ds_read_b64_tr_b16 a[156:157], v19 offset:16384
    v_cvt_pk_bf16_f32 v81, v66, v67
    v_mfma_f32_16x16x32_bf16 v[252:255], a[188:191], v[92:95], v[252:255]
    s_waitcnt lgkmcnt(8)
    v_exp_f32 v68, v68
    v_mfma_f32_16x16x32_bf16 v[72:75], a[96:99], a[0:3], v[48:51]
    ds_read_b64_tr_b16 a[158:159], v19 offset:20480
    v_mfma_f32_16x16x32_bf16 v[72:75], a[100:103], a[4:7], v[72:75]
    s_waitcnt vmcnt(0)
    v_exp_f32 v69, v69
    v_mfma_f32_16x16x32_bf16 v[72:75], a[104:107], a[8:11], v[72:75]
    s_barrier
    v_cvt_pk_bf16_f32 v82, v68, v69
    v_mfma_f32_16x16x32_bf16 v[72:75], a[108:111], a[12:15], v[72:75]
    v_exp_f32 v70, v70
    v_mfma_f32_16x16x32_bf16 v[76:79], a[112:115], a[0:3], v[48:51]
    s_waitcnt lgkmcnt(3)
    ds_read_b64_tr_b16 a[160:161], v12 offset:24576
    ds_read_b64_tr_b16 a[162:163], v12 offset:28672
    v_mfma_f32_16x16x32_bf16 v[76:79], a[116:119], a[4:7], v[76:79]
    v_exp_f32 v71, v71
    v_mfma_f32_16x16x32_bf16 v[76:79], a[120:123], a[8:11], v[76:79]
    ds_read_b64_tr_b16 a[164:165], v13 offset:24576
    v_cvt_pk_bf16_f32 v83, v70, v71
    v_mfma_f32_16x16x32_bf16 v[76:79], a[124:127], a[12:15], v[76:79]
    v_exp_f32 v72, v72
    v_mfma_f32_16x16x32_bf16 v[128:131], a[128:131], v[80:83], v[128:131]
    ds_read_b64_tr_b16 a[166:167], v13 offset:28672
    v_mfma_f32_16x16x32_bf16 v[132:135], a[132:135], v[80:83], v[132:135]
    v_exp_f32 v73, v73
    v_mfma_f32_16x16x32_bf16 v[136:139], a[136:139], v[80:83], v[136:139]
    ds_read_b64_tr_b16 a[168:169], v14 offset:24576
    v_cvt_pk_bf16_f32 v84, v72, v73
    v_mfma_f32_16x16x32_bf16 v[140:143], a[140:143], v[80:83], v[140:143]
    v_exp_f32 v74, v74
    v_mfma_f32_16x16x32_bf16 v[144:147], a[144:147], v[80:83], v[144:147]
    ds_read_b64_tr_b16 a[170:171], v14 offset:28672
    ds_read_b64_tr_b16 a[172:173], v15 offset:24576
    v_mfma_f32_16x16x32_bf16 v[148:151], a[148:151], v[80:83], v[148:151]
    s_waitcnt lgkmcnt(7)
    v_exp_f32 v75, v75
    v_mfma_f32_16x16x32_bf16 v[152:155], a[152:155], v[80:83], v[152:155]
    ds_read_b64_tr_b16 a[174:175], v15 offset:28672
    v_cvt_pk_bf16_f32 v85, v74, v75
    v_mfma_f32_16x16x32_bf16 v[156:159], a[156:159], v[80:83], v[156:159]
    v_exp_f32 v76, v76
    v_mfma_f32_16x16x32_bf16 v[64:67], a[64:67], a[16:19], v[52:55]
    ds_read_b64_tr_b16 a[176:177], v16 offset:24576
    v_mfma_f32_16x16x32_bf16 v[64:67], a[68:71], a[20:23], v[64:67]
    v_exp_f32 v77, v77
    v_mfma_f32_16x16x32_bf16 v[64:67], a[72:75], a[24:27], v[64:67]
    ds_read_b64_tr_b16 a[178:179], v16 offset:28672
    v_cvt_pk_bf16_f32 v86, v76, v77
    v_mfma_f32_16x16x32_bf16 v[64:67], a[76:79], a[28:31], v[64:67]
    v_exp_f32 v78, v78
    v_mfma_f32_16x16x32_bf16 v[68:71], a[80:83], a[16:19], v[52:55]
    ds_read_b64_tr_b16 a[180:181], v17 offset:24576
    ds_read_b64_tr_b16 a[182:183], v17 offset:28672
    v_mfma_f32_16x16x32_bf16 v[68:71], a[84:87], a[20:23], v[68:71]
    v_exp_f32 v79, v79
    v_mfma_f32_16x16x32_bf16 v[68:71], a[88:91], a[24:27], v[68:71]
    ds_read_b64_tr_b16 a[184:185], v18 offset:24576
    v_cvt_pk_bf16_f32 v87, v78, v79
    v_mfma_f32_16x16x32_bf16 v[68:71], a[92:95], a[28:31], v[68:71]
    v_exp_f32 v64, v64
    v_smfmac_f32_16x16x64_bf16 v[96:99], v[104:107], v[80:87], v116
    s_waitcnt lgkmcnt(5)
    ds_read_b64_tr_b16 a[186:187], v18 offset:28672
    v_mfma_f32_16x16x32_bf16 v[128:131], a[160:163], v[84:87], v[128:131]
    ds_read_b64_tr_b16 a[188:189], v19 offset:24576
    ds_read_b64_tr_b16 a[190:191], v19 offset:28672
    v_mfma_f32_16x16x32_bf16 v[132:135], a[164:167], v[84:87], v[132:135]
    v_exp_f32 v65, v65
    v_mfma_f32_16x16x32_bf16 v[136:139], a[168:171], v[84:87], v[136:139]
    v_cvt_pk_bf16_f32 v88, v64, v65
    v_mfma_f32_16x16x32_bf16 v[140:143], a[172:175], v[84:87], v[140:143]
    s_waitcnt lgkmcnt(5)
    v_exp_f32 v66, v66
    v_add_f32 v31, v96, v97
    v_rcp_f32 v30, v31
    v_mfma_f32_16x16x32_bf16 v[144:147], a[176:179], v[84:87], v[144:147]
    s_waitcnt lgkmcnt(3)
    v_cmp_nge_f32 vcc, s19, v31
    v_mul_f32 v128, v30, v128
    v_mul_f32 v129, v30, v129
    v_mul_f32 v130, v30, v130
    v_mul_f32 v131, v30, v131
    v_cvt_pk_bf16_f32 v128, v128, v129
    v_cvt_pk_bf16_f32 v129, v130, v131
    v_mfma_f32_16x16x32_bf16 v[148:151], a[180:183], v[84:87], v[148:151]
    s_cbranch_vccnz L_fallback
    v_exp_f32 v67, v67
    v_mul_f32 v132, v30, v132
    v_mul_f32 v133, v30, v133
    v_mul_f32 v134, v30, v134
    v_mul_f32 v135, v30, v135
    v_cvt_pk_bf16_f32 v132, v132, v133
    v_cvt_pk_bf16_f32 v133, v134, v135
    s_waitcnt lgkmcnt(0)
    v_mfma_f32_16x16x32_bf16 v[152:155], a[184:187], v[84:87], v[152:155]
    ds_write2_b64 v40, v[128:129], v[132:133] offset0:0 offset1:4
    v_cvt_pk_bf16_f32 v89, v66, v67
    v_mul_f32 v136, v30, v136
    v_mul_f32 v137, v30, v137
    v_mul_f32 v138, v30, v138
    v_mul_f32 v139, v30, v139
    v_cvt_pk_bf16_f32 v136, v136, v137
    v_cvt_pk_bf16_f32 v137, v138, v139
    v_mfma_f32_16x16x32_bf16 v[156:159], a[188:191], v[84:87], v[156:159]
    v_exp_f32 v68, v68
    v_mul_f32 v140, v30, v140
    v_mul_f32 v141, v30, v141
    v_mul_f32 v142, v30, v142
    v_mul_f32 v143, v30, v143
    v_cvt_pk_bf16_f32 v140, v140, v141
    v_cvt_pk_bf16_f32 v141, v142, v143
    v_mfma_f32_16x16x32_bf16 v[72:75], a[96:99], a[16:19], v[52:55]
    ds_write2_b64 v40, v[136:137], v[140:141] offset0:8 offset1:12
    v_pk_mul_f32 v[144:145], v[144:145], v[30:31] op_sel_hi:[1,0]
    v_pk_mul_f32 v[146:147], v[146:147], v[30:31] op_sel_hi:[1,0]
    v_pk_mul_f32 v[148:149], v[148:149], v[30:31] op_sel_hi:[1,0]
    v_pk_mul_f32 v[150:151], v[150:151], v[30:31] op_sel_hi:[1,0]
    v_pk_mul_f32 v[152:153], v[152:153], v[30:31] op_sel_hi:[1,0]
    v_pk_mul_f32 v[154:155], v[154:155], v[30:31] op_sel_hi:[1,0]
    v_pk_mul_f32 v[156:157], v[156:157], v[30:31] op_sel_hi:[1,0]
    v_pk_mul_f32 v[158:159], v[158:159], v[30:31] op_sel_hi:[1,0]
    v_cvt_pk_bf16_f32 v144, v144, v145
    v_cvt_pk_bf16_f32 v145, v146, v147
    v_cvt_pk_bf16_f32 v148, v148, v149
    v_cvt_pk_bf16_f32 v149, v150, v151
    v_cvt_pk_bf16_f32 v152, v152, v153
    v_cvt_pk_bf16_f32 v153, v154, v155
    v_cvt_pk_bf16_f32 v156, v156, v157
    v_cvt_pk_bf16_f32 v157, v158, v159
    v_mfma_f32_16x16x32_bf16 v[72:75], a[100:103], a[20:23], v[72:75]
    ds_read2_b64 v[128:131], v42 offset0:0 offset1:1
    ds_read2_b64 v[132:135], v42 offset0:136 offset1:137
    v_exp_f32 v69, v69
    v_mfma_f32_16x16x32_bf16 v[72:75], a[104:107], a[24:27], v[72:75]
    ds_write2_b64 v41, v[144:145], v[148:149] offset0:0 offset1:4
    v_cvt_pk_bf16_f32 v90, v68, v69
    v_mfma_f32_16x16x32_bf16 v[72:75], a[108:111], a[28:31], v[72:75]
    v_exp_f32 v70, v70
    v_mfma_f32_16x16x32_bf16 v[76:79], a[112:115], a[16:19], v[52:55]
    ds_write2_b64 v41, v[152:153], v[156:157] offset0:8 offset1:12
    v_mfma_f32_16x16x32_bf16 v[76:79], a[116:119], a[20:23], v[76:79]
    ds_read2_b64 v[144:147], v43 offset0:0 offset1:1
    ds_read2_b64 v[148:151], v43 offset0:136 offset1:137
    v_exp_f32 v71, v71
    v_mfma_f32_16x16x32_bf16 v[76:79], a[120:123], a[24:27], v[76:79]
    v_cvt_pk_bf16_f32 v91, v70, v71
    v_mfma_f32_16x16x32_bf16 v[76:79], a[124:127], a[28:31], v[76:79]
    v_exp_f32 v72, v72
    v_mfma_f32_16x16x32_bf16 v[160:163], a[128:131], v[88:91], v[160:163]
    s_waitcnt lgkmcnt(5)
    buffer_store_dwordx4 v[128:131], v44, s[32:35], 0 offen offset:0 sc1
    v_mfma_f32_16x16x32_bf16 v[164:167], a[132:135], v[88:91], v[164:167]
    v_exp_f32 v73, v73
    v_mfma_f32_16x16x32_bf16 v[168:171], a[136:139], v[88:91], v[168:171]
    v_cvt_pk_bf16_f32 v92, v72, v73
    v_mfma_f32_16x16x32_bf16 v[172:175], a[140:143], v[88:91], v[172:175]
    v_exp_f32 v74, v74
    v_mfma_f32_16x16x32_bf16 v[176:179], a[144:147], v[88:91], v[176:179]
    s_waitcnt lgkmcnt(3)
    buffer_store_dwordx4 v[132:135], v44, s[32:35], 0 offen offset:2048 sc1
    v_mfma_f32_16x16x32_bf16 v[180:183], a[148:151], v[88:91], v[180:183]
    v_exp_f32 v75, v75
    v_mfma_f32_16x16x32_bf16 v[184:187], a[152:155], v[88:91], v[184:187]
    v_cvt_pk_bf16_f32 v93, v74, v75
    v_mfma_f32_16x16x32_bf16 v[188:191], a[156:159], v[88:91], v[188:191]
    v_exp_f32 v76, v76
    v_mfma_f32_16x16x32_bf16 v[64:67], a[64:67], a[32:35], v[56:59]
    s_waitcnt lgkmcnt(0)
    buffer_store_dwordx4 v[144:147], v44, s[32:35], 0 offen offset:128 sc1
    v_mfma_f32_16x16x32_bf16 v[64:67], a[68:71], a[36:39], v[64:67]
    v_exp_f32 v77, v77
    v_mfma_f32_16x16x32_bf16 v[64:67], a[72:75], a[40:43], v[64:67]
    v_cvt_pk_bf16_f32 v94, v76, v77
    v_mfma_f32_16x16x32_bf16 v[64:67], a[76:79], a[44:47], v[64:67]
    v_exp_f32 v78, v78
    v_mfma_f32_16x16x32_bf16 v[68:71], a[80:83], a[32:35], v[56:59]
    buffer_store_dwordx4 v[148:151], v44, s[32:35], 0 offen offset:2176 sc1
    v_mfma_f32_16x16x32_bf16 v[68:71], a[84:87], a[36:39], v[68:71]
    v_exp_f32 v79, v79
    v_mfma_f32_16x16x32_bf16 v[68:71], a[88:91], a[40:43], v[68:71]
    v_cvt_pk_bf16_f32 v95, v78, v79
    v_mfma_f32_16x16x32_bf16 v[68:71], a[92:95], a[44:47], v[68:71]
    v_exp_f32 v64, v64
    v_smfmac_f32_16x16x64_bf16 v[96:99], v[108:111], v[88:95], v116
    v_mfma_f32_16x16x32_bf16 v[160:163], a[160:163], v[92:95], v[160:163]
    v_mfma_f32_16x16x32_bf16 v[164:167], a[164:167], v[92:95], v[164:167]
    v_exp_f32 v65, v65
    v_mfma_f32_16x16x32_bf16 v[168:171], a[168:171], v[92:95], v[168:171]
    v_cvt_pk_bf16_f32 v80, v64, v65
    v_mfma_f32_16x16x32_bf16 v[172:175], a[172:175], v[92:95], v[172:175]
    v_exp_f32 v66, v66
    s_nop 0
    v_add_f32 v33, v98, v99
    v_rcp_f32 v32, v33
    v_mfma_f32_16x16x32_bf16 v[176:179], a[176:179], v[92:95], v[176:179]
    v_cmp_nge_f32 vcc, s19, v33
    v_mul_f32 v160, v32, v160
    v_mul_f32 v161, v32, v161
    v_mul_f32 v162, v32, v162
    v_mul_f32 v163, v32, v163
    v_cvt_pk_bf16_f32 v160, v160, v161
    v_cvt_pk_bf16_f32 v161, v162, v163
    v_mfma_f32_16x16x32_bf16 v[180:183], a[180:183], v[92:95], v[180:183]
    s_cbranch_vccnz L_fallback
    v_exp_f32 v67, v67
    v_mul_f32 v164, v32, v164
    v_mul_f32 v165, v32, v165
    v_mul_f32 v166, v32, v166
    v_mul_f32 v167, v32, v167
    v_cvt_pk_bf16_f32 v164, v164, v165
    v_cvt_pk_bf16_f32 v165, v166, v167
    v_mfma_f32_16x16x32_bf16 v[184:187], a[184:187], v[92:95], v[184:187]
    ds_write2_b64 v40, v[160:161], v[164:165] offset0:0 offset1:4
    v_cvt_pk_bf16_f32 v81, v66, v67
    v_mul_f32 v168, v32, v168
    v_mul_f32 v169, v32, v169
    v_mul_f32 v170, v32, v170
    v_mul_f32 v171, v32, v171
    v_cvt_pk_bf16_f32 v168, v168, v169
    v_cvt_pk_bf16_f32 v169, v170, v171
    v_mfma_f32_16x16x32_bf16 v[188:191], a[188:191], v[92:95], v[188:191]
    s_xor_b32 s32, s67, 4096
    v_exp_f32 v68, v68
    v_mul_f32 v172, v32, v172
    v_mul_f32 v173, v32, v173
    v_mul_f32 v174, v32, v174
    v_mul_f32 v175, v32, v175
    v_cvt_pk_bf16_f32 v172, v172, v173
    v_cvt_pk_bf16_f32 v173, v174, v175
    v_mfma_f32_16x16x32_bf16 v[72:75], a[96:99], a[32:35], v[56:59]
    ds_write2_b64 v40, v[168:169], v[172:173] offset0:8 offset1:12
    v_pk_mul_f32 v[176:177], v[176:177], v[32:33] op_sel_hi:[1,0]
    v_pk_mul_f32 v[178:179], v[178:179], v[32:33] op_sel_hi:[1,0]
    v_pk_mul_f32 v[180:181], v[180:181], v[32:33] op_sel_hi:[1,0]
    v_pk_mul_f32 v[182:183], v[182:183], v[32:33] op_sel_hi:[1,0]
    v_pk_mul_f32 v[184:185], v[184:185], v[32:33] op_sel_hi:[1,0]
    v_pk_mul_f32 v[186:187], v[186:187], v[32:33] op_sel_hi:[1,0]
    v_pk_mul_f32 v[188:189], v[188:189], v[32:33] op_sel_hi:[1,0]
    v_pk_mul_f32 v[190:191], v[190:191], v[32:33] op_sel_hi:[1,0]
    v_cvt_pk_bf16_f32 v176, v176, v177
    v_cvt_pk_bf16_f32 v177, v178, v179
    v_cvt_pk_bf16_f32 v180, v180, v181
    v_cvt_pk_bf16_f32 v181, v182, v183
    v_cvt_pk_bf16_f32 v184, v184, v185
    v_cvt_pk_bf16_f32 v185, v186, v187
    v_cvt_pk_bf16_f32 v188, v188, v189
    v_cvt_pk_bf16_f32 v189, v190, v191
    v_mfma_f32_16x16x32_bf16 v[72:75], a[100:103], a[36:39], v[72:75]
    ds_read2_b64 v[160:163], v42 offset0:0 offset1:1
    ds_read2_b64 v[164:167], v42 offset0:136 offset1:137
    v_exp_f32 v69, v69
    v_mfma_f32_16x16x32_bf16 v[72:75], a[104:107], a[40:43], v[72:75]
    ds_write2_b64 v41, v[176:177], v[180:181] offset0:0 offset1:4
    v_cvt_pk_bf16_f32 v82, v68, v69
    v_mfma_f32_16x16x32_bf16 v[72:75], a[108:111], a[44:47], v[72:75]
    v_exp_f32 v70, v70
    v_mfma_f32_16x16x32_bf16 v[76:79], a[112:115], a[32:35], v[56:59]
    ds_write2_b64 v41, v[184:185], v[188:189] offset0:8 offset1:12
    v_mfma_f32_16x16x32_bf16 v[76:79], a[116:119], a[36:39], v[76:79]
    ds_read2_b64 v[176:179], v43 offset0:0 offset1:1
    ds_read2_b64 v[180:183], v43 offset0:136 offset1:137
    v_exp_f32 v71, v71
    v_mfma_f32_16x16x32_bf16 v[76:79], a[120:123], a[40:43], v[76:79]
    s_waitcnt lgkmcnt(5)
    buffer_store_dwordx4 v[160:163], v44, s[32:35], 0 offen offset:0 sc1
    v_cvt_pk_bf16_f32 v83, v70, v71
    v_mfma_f32_16x16x32_bf16 v[76:79], a[124:127], a[44:47], v[76:79]
    v_exp_f32 v72, v72
    v_mfma_f32_16x16x32_bf16 v[192:195], a[128:131], v[80:83], v[192:195]
    s_waitcnt lgkmcnt(4)
    buffer_store_dwordx4 v[164:167], v44, s[32:35], 0 offen offset:2048 sc1
    v_mfma_f32_16x16x32_bf16 v[196:199], a[132:135], v[80:83], v[196:199]
    v_exp_f32 v73, v73
    v_mfma_f32_16x16x32_bf16 v[200:203], a[136:139], v[80:83], v[200:203]
    s_waitcnt lgkmcnt(1)
    buffer_store_dwordx4 v[176:179], v44, s[32:35], 0 offen offset:128 sc1
    v_cvt_pk_bf16_f32 v84, v72, v73
    v_mfma_f32_16x16x32_bf16 v[204:207], a[140:143], v[80:83], v[204:207]
    v_exp_f32 v74, v74
    v_mfma_f32_16x16x32_bf16 v[208:211], a[144:147], v[80:83], v[208:211]
    s_waitcnt lgkmcnt(0)
    buffer_store_dwordx4 v[180:183], v44, s[32:35], 0 offen offset:2176 sc1
    v_mfma_f32_16x16x32_bf16 v[212:215], a[148:151], v[80:83], v[212:215]
    v_exp_f32 v75, v75
    v_mfma_f32_16x16x32_bf16 v[216:219], a[152:155], v[80:83], v[216:219]
    v_cvt_pk_bf16_f32 v85, v74, v75
    v_mfma_f32_16x16x32_bf16 v[220:223], a[156:159], v[80:83], v[220:223]
    v_exp_f32 v76, v76
    v_mfma_f32_16x16x32_bf16 v[64:67], a[64:67], a[48:51], v[60:63]
    v_mfma_f32_16x16x32_bf16 v[64:67], a[68:71], a[52:55], v[64:67]
    v_exp_f32 v77, v77
    v_mfma_f32_16x16x32_bf16 v[64:67], a[72:75], a[56:59], v[64:67]
    v_cvt_pk_bf16_f32 v86, v76, v77
    v_mfma_f32_16x16x32_bf16 v[64:67], a[76:79], a[60:63], v[64:67]
    v_exp_f32 v78, v78
    v_mfma_f32_16x16x32_bf16 v[68:71], a[80:83], a[48:51], v[60:63]
    v_mfma_f32_16x16x32_bf16 v[68:71], a[84:87], a[52:55], v[68:71]
    v_exp_f32 v79, v79
    v_mfma_f32_16x16x32_bf16 v[68:71], a[88:91], a[56:59], v[68:71]
    v_cvt_pk_bf16_f32 v87, v78, v79
    v_mfma_f32_16x16x32_bf16 v[68:71], a[92:95], a[60:63], v[68:71]
    s_nop 0
    v_exp_f32 v64, v64
    v_smfmac_f32_16x16x64_bf16 v[100:103], v[104:107], v[80:87], v116
    v_mfma_f32_16x16x32_bf16 v[192:195], a[160:163], v[84:87], v[192:195]
L_hop4:
    s_cbranch_execz L_hop_back
    v_mfma_f32_16x16x32_bf16 v[196:199], a[164:167], v[84:87], v[196:199]
    v_exp_f32 v65, v65
    v_mfma_f32_16x16x32_bf16 v[200:203], a[168:171], v[84:87], v[200:203]
    v_cvt_pk_bf16_f32 v88, v64, v65
    v_mfma_f32_16x16x32_bf16 v[204:207], a[172:175], v[84:87], v[204:207]
    v_exp_f32 v66, v66
    s_nop 0
    v_add_f32 v35, v100, v101
    v_rcp_f32 v34, v35
    v_mfma_f32_16x16x32_bf16 v[208:211], a[176:179], v[84:87], v[208:211]
    v_cmp_nge_f32 vcc, s19, v35
    v_mul_f32 v192, v34, v192
    v_mul_f32 v193, v34, v193
    v_mul_f32 v194, v34, v194
    v_mul_f32 v195, v34, v195
    v_cvt_pk_bf16_f32 v192, v192, v193
    v_cvt_pk_bf16_f32 v193, v194, v195
    v_mfma_f32_16x16x32_bf16 v[212:215], a[180:183], v[84:87], v[212:215]
    s_cbranch_vccnz L_fallback
    v_exp_f32 v67, v67
    v_mul_f32 v196, v34, v196
    v_mul_f32 v197, v34, v197
    v_mul_f32 v198, v34, v198
    v_mul_f32 v199, v34, v199
    v_cvt_pk_bf16_f32 v196, v196, v197
    v_cvt_pk_bf16_f32 v197, v198, v199
    v_mfma_f32_16x16x32_bf16 v[216:219], a[184:187], v[84:87], v[216:219]
    ds_write2_b64 v40, v[192:193], v[196:197] offset0:0 offset1:4
    v_cvt_pk_bf16_f32 v89, v66, v67
    v_mul_f32 v200, v34, v200
    v_mul_f32 v201, v34, v201
    v_mul_f32 v202, v34, v202
    v_mul_f32 v203, v34, v203
    v_cvt_pk_bf16_f32 v200, v200, v201
    v_cvt_pk_bf16_f32 v201, v202, v203
    v_mfma_f32_16x16x32_bf16 v[220:223], a[188:191], v[84:87], v[220:223]
    s_xor_b32 s32, s67, 8192
    v_exp_f32 v68, v68
    v_mul_f32 v204, v34, v204
    v_mul_f32 v205, v34, v205
    v_mul_f32 v206, v34, v206
    v_mul_f32 v207, v34, v207
    v_cvt_pk_bf16_f32 v204, v204, v205
    v_cvt_pk_bf16_f32 v205, v206, v207
    v_mfma_f32_16x16x32_bf16 v[72:75], a[96:99], a[48:51], v[60:63]
    ds_write2_b64 v40, v[200:201], v[204:205] offset0:8 offset1:12
    v_pk_mul_f32 v[208:209], v[208:209], v[34:35] op_sel_hi:[1,0]
    v_pk_mul_f32 v[210:211], v[210:211], v[34:35] op_sel_hi:[1,0]
    v_pk_mul_f32 v[212:213], v[212:213], v[34:35] op_sel_hi:[1,0]
    v_pk_mul_f32 v[214:215], v[214:215], v[34:35] op_sel_hi:[1,0]
    v_pk_mul_f32 v[216:217], v[216:217], v[34:35] op_sel_hi:[1,0]
    v_pk_mul_f32 v[218:219], v[218:219], v[34:35] op_sel_hi:[1,0]
    v_pk_mul_f32 v[220:221], v[220:221], v[34:35] op_sel_hi:[1,0]
    v_pk_mul_f32 v[222:223], v[222:223], v[34:35] op_sel_hi:[1,0]
    v_cvt_pk_bf16_f32 v208, v208, v209
    v_cvt_pk_bf16_f32 v209, v210, v211
    v_cvt_pk_bf16_f32 v212, v212, v213
    v_cvt_pk_bf16_f32 v213, v214, v215
    v_cvt_pk_bf16_f32 v216, v216, v217
    v_cvt_pk_bf16_f32 v217, v218, v219
    v_cvt_pk_bf16_f32 v220, v220, v221
    v_cvt_pk_bf16_f32 v221, v222, v223
    v_mfma_f32_16x16x32_bf16 v[72:75], a[100:103], a[52:55], v[72:75]
    ds_read2_b64 v[192:195], v42 offset0:0 offset1:1
    ds_read2_b64 v[196:199], v42 offset0:136 offset1:137
    v_exp_f32 v69, v69
    v_mfma_f32_16x16x32_bf16 v[72:75], a[104:107], a[56:59], v[72:75]
    ds_write2_b64 v41, v[208:209], v[212:213] offset0:0 offset1:4
    v_cvt_pk_bf16_f32 v90, v68, v69
    v_mfma_f32_16x16x32_bf16 v[72:75], a[108:111], a[60:63], v[72:75]
    v_exp_f32 v70, v70
    v_mfma_f32_16x16x32_bf16 v[76:79], a[112:115], a[48:51], v[60:63]
    ds_write2_b64 v41, v[216:217], v[220:221] offset0:8 offset1:12
    v_mfma_f32_16x16x32_bf16 v[76:79], a[116:119], a[52:55], v[76:79]
    ds_read2_b64 v[208:211], v43 offset0:0 offset1:1
    ds_read2_b64 v[212:215], v43 offset0:136 offset1:137
    v_exp_f32 v71, v71
    v_mfma_f32_16x16x32_bf16 v[76:79], a[120:123], a[56:59], v[76:79]
    s_waitcnt lgkmcnt(5)
    buffer_store_dwordx4 v[192:195], v44, s[32:35], 0 offen offset:0 sc1
    v_cvt_pk_bf16_f32 v91, v70, v71
    v_mfma_f32_16x16x32_bf16 v[76:79], a[124:127], a[60:63], v[76:79]
    v_exp_f32 v72, v72
    v_mfma_f32_16x16x32_bf16 v[224:227], a[128:131], v[88:91], v[224:227]
    s_waitcnt lgkmcnt(4)
    buffer_store_dwordx4 v[196:199], v44, s[32:35], 0 offen offset:2048 sc1
    v_exp_f32 v73, v73
    v_mfma_f32_16x16x32_bf16 v[228:231], a[132:135], v[88:91], v[228:231]
    v_exp_f32 v74, v74
    v_cvt_pk_bf16_f32 v92, v72, v73
    v_mfma_f32_16x16x32_bf16 v[232:235], a[136:139], v[88:91], v[232:235]
    s_waitcnt lgkmcnt(1)
    buffer_store_dwordx4 v[208:211], v44, s[32:35], 0 offen offset:128 sc1
    v_exp_f32 v75, v75
    v_mfma_f32_16x16x32_bf16 v[236:239], a[140:143], v[88:91], v[236:239]
    v_cvt_pk_bf16_f32 v93, v74, v75
    v_mfma_f32_16x16x32_bf16 v[240:243], a[144:147], v[88:91], v[240:243]
    s_waitcnt lgkmcnt(0)
    buffer_store_dwordx4 v[212:215], v44, s[32:35], 0 offen offset:2176 sc1
    v_exp_f32 v76, v76
    v_mfma_f32_16x16x32_bf16 v[244:247], a[148:151], v[88:91], v[244:247]
    v_exp_f32 v77, v77
    v_mfma_f32_16x16x32_bf16 v[248:251], a[152:155], v[88:91], v[248:251]
    v_exp_f32 v78, v78
    v_cvt_pk_bf16_f32 v94, v76, v77
    v_mfma_f32_16x16x32_bf16 v[252:255], a[156:159], v[88:91], v[252:255]
    v_exp_f32 v79, v79
    s_nop 0
    v_cvt_pk_bf16_f32 v95, v78, v79
    s_nop 1
    v_smfmac_f32_16x16x64_bf16 v[100:103], v[108:111], v[88:95], v116
    v_mfma_f32_16x16x32_bf16 v[224:227], a[160:163], v[92:95], v[224:227]
    v_mfma_f32_16x16x32_bf16 v[228:231], a[164:167], v[92:95], v[228:231]
    v_mfma_f32_16x16x32_bf16 v[232:235], a[168:171], v[92:95], v[232:235]
    v_mfma_f32_16x16x32_bf16 v[236:239], a[172:175], v[92:95], v[236:239]
    s_nop 3
    v_add_f32 v37, v102, v103
    v_rcp_f32 v36, v37
    v_mfma_f32_16x16x32_bf16 v[240:243], a[176:179], v[92:95], v[240:243]
    v_cmp_nge_f32 vcc, s19, v37
    v_mul_f32 v224, v36, v224
    v_mul_f32 v225, v36, v225
    v_mul_f32 v226, v36, v226
    v_mul_f32 v227, v36, v227
    v_cvt_pk_bf16_f32 v224, v224, v225
    v_cvt_pk_bf16_f32 v225, v226, v227
    v_mfma_f32_16x16x32_bf16 v[244:247], a[180:183], v[92:95], v[244:247]
    s_cbranch_vccnz L_fallback
    v_mul_f32 v228, v36, v228
    v_mul_f32 v229, v36, v229
    v_mul_f32 v230, v36, v230
    v_mul_f32 v231, v36, v231
    v_cvt_pk_bf16_f32 v228, v228, v229
    v_cvt_pk_bf16_f32 v229, v230, v231
    v_mfma_f32_16x16x32_bf16 v[248:251], a[184:187], v[92:95], v[248:251]
    ds_write2_b64 v40, v[224:225], v[228:229] offset0:0 offset1:4
    v_mul_f32 v232, v36, v232
    v_mul_f32 v233, v36, v233
    v_mul_f32 v234, v36, v234
    v_mul_f32 v235, v36, v235
    v_cvt_pk_bf16_f32 v232, v232, v233
    v_cvt_pk_bf16_f32 v233, v234, v235
    v_mfma_f32_16x16x32_bf16 v[252:255], a[188:191], v[92:95], v[252:255]
    s_xor_b32 s32, s67, 12288
    v_mul_f32 v236, v36, v236
    v_mul_f32 v237, v36, v237
    v_mul_f32 v238, v36, v238
    v_mul_f32 v239, v36, v239
    v_cvt_pk_bf16_f32 v236, v236, v237
    v_cvt_pk_bf16_f32 v237, v238, v239
    ds_write2_b64 v40, v[232:233], v[236:237] offset0:8 offset1:12
    ds_read2_b64 v[224:227], v42 offset0:0 offset1:1
    ds_read2_b64 v[228:231], v42 offset0:136 offset1:137
    v_pk_mul_f32 v[240:241], v[240:241], v[36:37] op_sel_hi:[1,0]
    v_pk_mul_f32 v[242:243], v[242:243], v[36:37] op_sel_hi:[1,0]
    v_pk_mul_f32 v[244:245], v[244:245], v[36:37] op_sel_hi:[1,0]
    v_pk_mul_f32 v[246:247], v[246:247], v[36:37] op_sel_hi:[1,0]
    v_pk_mul_f32 v[248:249], v[248:249], v[36:37] op_sel_hi:[1,0]
    v_pk_mul_f32 v[250:251], v[250:251], v[36:37] op_sel_hi:[1,0]
    v_pk_mul_f32 v[252:253], v[252:253], v[36:37] op_sel_hi:[1,0]
    v_pk_mul_f32 v[254:255], v[254:255], v[36:37] op_sel_hi:[1,0]
    v_cvt_pk_bf16_f32 v240, v240, v241
    v_cvt_pk_bf16_f32 v241, v242, v243
    v_cvt_pk_bf16_f32 v244, v244, v245
    v_cvt_pk_bf16_f32 v245, v246, v247
    v_cvt_pk_bf16_f32 v248, v248, v249
    v_cvt_pk_bf16_f32 v249, v250, v251
    v_cvt_pk_bf16_f32 v252, v252, v253
    v_cvt_pk_bf16_f32 v253, v254, v255
    ds_write2_b64 v41, v[240:241], v[244:245] offset0:0 offset1:4
    ds_write2_b64 v41, v[248:249], v[252:253] offset0:8 offset1:12
    ds_read2_b64 v[240:243], v43 offset0:0 offset1:1
    ds_read2_b64 v[244:247], v43 offset0:136 offset1:137
    s_waitcnt lgkmcnt(5)
    buffer_store_dwordx4 v[224:227], v44, s[32:35], 0 offen offset:0 sc1
    s_waitcnt lgkmcnt(4)
    buffer_store_dwordx4 v[228:231], v44, s[32:35], 0 offen offset:2048 sc1
    s_waitcnt lgkmcnt(1)
    buffer_store_dwordx4 v[240:243], v44, s[32:35], 0 offen offset:128 sc1
    s_waitcnt lgkmcnt(0)
    buffer_store_dwordx4 v[244:247], v44, s[32:35], 0 offen offset:2176 sc1
L_end:
    s_endpgm
L_fallback:
    s_waitcnt vmcnt(0) lgkmcnt(0)
    s_nop 7
    s_lshl_b32 s38, s2, 17
    s_add_u32 s36, s6, s38
    s_addc_u32 s37, s7, 0
    s_add_u32 s40, s8, s38
    s_addc_u32 s41, s9, 0
    s_mov_b32 s38, 0x20000
    s_mov_b32 s39, 0x20000
    s_mov_b32 s42, 0x20000
    s_mov_b32 s43, 0x20000
    v_and_b32 v3, 15, v25
    v_lshrrev_b32 v2, 4, v25
    v_lshlrev_b32 v4, 4, v2
    v_lshl_add_u32 v1, v3, 8, v4
    v_lshlrev_b32 v4, 1, v2
    v_xor_b32 v4, v4, v3
    v_lshlrev_b32 v4, 4, v4
    v_lshl_add_u32 v22, v2, 8, v4
    v_xor_b32 v23, 0x80, v22
    s_sub_u32 s13, s16, 49152
    v_mov_b32 v96, 0xff800000
    v_mov_b32 v97, 0xff800000
    v_mov_b32 v98, 0xff800000
    v_mov_b32 v99, 0xff800000
    v_add_u32 v104, s13, v12
    v_add_u32 v105, s13, v13
    v_add_u32 v106, s13, v14
    v_add_u32 v107, s13, v15
    v_add_u32 v108, s13, v16
    v_add_u32 v109, s13, v17
    v_add_u32 v110, s13, v18
    v_add_u32 v111, s13, v19
    s_mov_b32 s12, 0
L_fb_max:
    s_add_u32 s13, s12, 4096
    buffer_load_dwordx4 a[64:67], v1, s[36:39], s12 offen offset:0
    buffer_load_dwordx4 a[68:71], v1, s[36:39], s12 offen offset:64
    buffer_load_dwordx4 a[72:75], v1, s[36:39], s12 offen offset:128
    buffer_load_dwordx4 a[76:79], v1, s[36:39], s12 offen offset:192
    buffer_load_dwordx4 a[80:83], v1, s[36:39], s13 offen offset:0
    buffer_load_dwordx4 a[84:87], v1, s[36:39], s13 offen offset:64
    buffer_load_dwordx4 a[88:91], v1, s[36:39], s13 offen offset:128
    buffer_load_dwordx4 a[92:95], v1, s[36:39], s13 offen offset:192
    s_waitcnt vmcnt(0)
    v_mfma_f32_16x16x32_bf16 v[64:67], a[64:67], a[0:3], 0
    v_mfma_f32_16x16x32_bf16 v[64:67], a[68:71], a[4:7], v[64:67]
    v_mfma_f32_16x16x32_bf16 v[64:67], a[72:75], a[8:11], v[64:67]
    v_mfma_f32_16x16x32_bf16 v[64:67], a[76:79], a[12:15], v[64:67]
    v_mfma_f32_16x16x32_bf16 v[68:71], a[80:83], a[0:3], 0
    v_mfma_f32_16x16x32_bf16 v[68:71], a[84:87], a[4:7], v[68:71]
    v_mfma_f32_16x16x32_bf16 v[68:71], a[88:91], a[8:11], v[68:71]
    v_mfma_f32_16x16x32_bf16 v[68:71], a[92:95], a[12:15], v[68:71]
    s_nop 3
    v_max3_f32 v96, v96, v64, v65
    v_max3_f32 v96, v96, v66, v67
    s_nop 1
    v_max3_f32 v96, v96, v68, v69
    v_max3_f32 v96, v96, v70, v71
    v_mfma_f32_16x16x32_bf16 v[72:75], a[64:67], a[16:19], 0
    v_mfma_f32_16x16x32_bf16 v[72:75], a[68:71], a[20:23], v[72:75]
    v_mfma_f32_16x16x32_bf16 v[72:75], a[72:75], a[24:27], v[72:75]
    v_mfma_f32_16x16x32_bf16 v[72:75], a[76:79], a[28:31], v[72:75]
    v_mfma_f32_16x16x32_bf16 v[76:79], a[80:83], a[16:19], 0
    v_mfma_f32_16x16x32_bf16 v[76:79], a[84:87], a[20:23], v[76:79]
    v_mfma_f32_16x16x32_bf16 v[76:79], a[88:91], a[24:27], v[76:79]
    v_mfma_f32_16x16x32_bf16 v[76:79], a[92:95], a[28:31], v[76:79]
    s_nop 3
    v_max3_f32 v97, v97, v72, v73
    v_max3_f32 v97, v97, v74, v75
    s_nop 1
    v_max3_f32 v97, v97, v76, v77
    v_max3_f32 v97, v97, v78, v79
    v_mfma_f32_16x16x32_bf16 v[64:67], a[64:67], a[32:35], 0
    v_mfma_f32_16x16x32_bf16 v[64:67], a[68:71], a[36:39], v[64:67]
    v_mfma_f32_16x16x32_bf16 v[64:67], a[72:75], a[40:43], v[64:67]
    v_mfma_f32_16x16x32_bf16 v[64:67], a[76:79], a[44:47], v[64:67]
    v_mfma_f32_16x16x32_bf16 v[68:71], a[80:83], a[32:35], 0
    v_mfma_f32_16x16x32_bf16 v[68:71], a[84:87], a[36:39], v[68:71]
    v_mfma_f32_16x16x32_bf16 v[68:71], a[88:91], a[40:43], v[68:71]
    v_mfma_f32_16x16x32_bf16 v[68:71], a[92:95], a[44:47], v[68:71]
    s_nop 3
    v_max3_f32 v98, v98, v64, v65
    v_max3_f32 v98, v98, v66, v67
    s_nop 1
    v_max3_f32 v98, v98, v68, v69
    v_max3_f32 v98, v98, v70, v71
    v_mfma_f32_16x16x32_bf16 v[72:75], a[64:67], a[48:51], 0
    v_mfma_f32_16x16x32_bf16 v[72:75], a[68:71], a[52:55], v[72:75]
    v_mfma_f32_16x16x32_bf16 v[72:75], a[72:75], a[56:59], v[72:75]
    v_mfma_f32_16x16x32_bf16 v[72:75], a[76:79], a[60:63], v[72:75]
    v_mfma_f32_16x16x32_bf16 v[76:79], a[80:83], a[48:51], 0
    v_mfma_f32_16x16x32_bf16 v[76:79], a[84:87], a[52:55], v[76:79]
    v_mfma_f32_16x16x32_bf16 v[76:79], a[88:91], a[56:59], v[76:79]
    v_mfma_f32_16x16x32_bf16 v[76:79], a[92:95], a[60:63], v[76:79]
    s_nop 3
    v_max3_f32 v99, v99, v72, v73
    v_max3_f32 v99, v99, v74, v75
    s_nop 1
    v_max3_f32 v99, v99, v76, v77
    v_max3_f32 v99, v99, v78, v79
    s_add_u32 s12, s12, 8192
    s_cmp_lt_u32 s12, 0x20000
    s_cbranch_scc1 L_fb_max
    v_mov_b32 v30, v96
    s_nop 1
    v_permlane16_swap_b32 v96, v30
    v_max_f32 v96, v96, v30
    v_mov_b32 v30, v96
    s_nop 1
    v_permlane32_swap_b32 v96, v30
    v_max_f32 v96, v96, v30
    v_sub_f32 v48, 0, v96
    v_sub_f32 v49, 0, v96
    v_sub_f32 v50, 0, v96
    v_sub_f32 v51, 0, v96
    v_mov_b32 v26, 0
    v_mov_b32 v30, v97
    s_nop 1
    v_permlane16_swap_b32 v97, v30
    v_max_f32 v97, v97, v30
    v_mov_b32 v30, v97
    s_nop 1
    v_permlane32_swap_b32 v97, v30
    v_max_f32 v97, v97, v30
    v_sub_f32 v52, 0, v97
    v_sub_f32 v53, 0, v97
    v_sub_f32 v54, 0, v97
    v_sub_f32 v55, 0, v97
    v_mov_b32 v27, 0
    v_mov_b32 v30, v98
    s_nop 1
    v_permlane16_swap_b32 v98, v30
    v_max_f32 v98, v98, v30
    v_mov_b32 v30, v98
    s_nop 1
    v_permlane32_swap_b32 v98, v30
    v_max_f32 v98, v98, v30
    v_sub_f32 v56, 0, v98
    v_sub_f32 v57, 0, v98
    v_sub_f32 v58, 0, v98
    v_sub_f32 v59, 0, v98
    v_mov_b32 v28, 0
    v_mov_b32 v30, v99
    s_nop 1
    v_permlane16_swap_b32 v99, v30
    v_max_f32 v99, v99, v30
    v_mov_b32 v30, v99
    s_nop 1
    v_permlane32_swap_b32 v99, v30
    v_max_f32 v99, v99, v30
    v_sub_f32 v60, 0, v99
    v_sub_f32 v61, 0, v99
    v_sub_f32 v62, 0, v99
    v_sub_f32 v63, 0, v99
    v_mov_b32 v29, 0
    v_mov_b32 v128, 0
    v_mov_b32 v129, 0
    v_mov_b32 v130, 0
    v_mov_b32 v131, 0
    v_mov_b32 v132, 0
    v_mov_b32 v133, 0
    v_mov_b32 v134, 0
    v_mov_b32 v135, 0
    v_mov_b32 v136, 0
    v_mov_b32 v137, 0
    v_mov_b32 v138, 0
    v_mov_b32 v139, 0
    v_mov_b32 v140, 0
    v_mov_b32 v141, 0
    v_mov_b32 v142, 0
    v_mov_b32 v143, 0
    v_mov_b32 v144, 0
    v_mov_b32 v145, 0
    v_mov_b32 v146, 0
    v_mov_b32 v147, 0
    v_mov_b32 v148, 0
    v_mov_b32 v149, 0
    v_mov_b32 v150, 0
    v_mov_b32 v151, 0
    v_mov_b32 v152, 0
    v_mov_b32 v153, 0
    v_mov_b32 v154, 0
    v_mov_b32 v155, 0
    v_mov_b32 v156, 0
    v_mov_b32 v157, 0
    v_mov_b32 v158, 0
    v_mov_b32 v159, 0
    v_mov_b32 v160, 0
    v_mov_b32 v161, 0
    v_mov_b32 v162, 0
    v_mov_b32 v163, 0
    v_mov_b32 v164, 0
    v_mov_b32 v165, 0
    v_mov_b32 v166, 0
    v_mov_b32 v167, 0
    v_mov_b32 v168, 0
    v_mov_b32 v169, 0
    v_mov_b32 v170, 0
    v_mov_b32 v171, 0
    v_mov_b32 v172, 0
    v_mov_b32 v173, 0
    v_mov_b32 v174, 0
    v_mov_b32 v175, 0
    v_mov_b32 v176, 0
    v_mov_b32 v177, 0
    v_mov_b32 v178, 0
    v_mov_b32 v179, 0
    v_mov_b32 v180, 0
    v_mov_b32 v181, 0
    v_mov_b32 v182, 0
    v_mov_b32 v183, 0
    v_mov_b32 v184, 0
    v_mov_b32 v185, 0
    v_mov_b32 v186, 0
    v_mov_b32 v187, 0
    v_mov_b32 v188, 0
    v_mov_b32 v189, 0
    v_mov_b32 v190, 0
    v_mov_b32 v191, 0
    v_mov_b32 v192, 0
    v_mov_b32 v193, 0
    v_mov_b32 v194, 0
    v_mov_b32 v195, 0
    v_mov_b32 v196, 0
    v_mov_b32 v197, 0
    v_mov_b32 v198, 0
    v_mov_b32 v199, 0
    v_mov_b32 v200, 0
    v_mov_b32 v201, 0
    v_mov_b32 v202, 0
    v_mov_b32 v203, 0
    v_mov_b32 v204, 0
    v_mov_b32 v205, 0
    v_mov_b32 v206, 0
    v_mov_b32 v207, 0
    v_mov_b32 v208, 0
    v_mov_b32 v209, 0
    v_mov_b32 v210, 0
    v_mov_b32 v211, 0
    v_mov_b32 v212, 0
    v_mov_b32 v213, 0
    v_mov_b32 v214, 0
    v_mov_b32 v215, 0
    v_mov_b32 v216, 0
    v_mov_b32 v217, 0
    v_mov_b32 v218, 0
    v_mov_b32 v219, 0
    v_mov_b32 v220, 0
    v_mov_b32 v221, 0
    v_mov_b32 v222, 0
    v_mov_b32 v223, 0
    v_mov_b32 v224, 0
    v_mov_b32 v225, 0
    v_mov_b32 v226, 0
    v_mov_b32 v227, 0
    v_mov_b32 v228, 0
    v_mov_b32 v229, 0
    v_mov_b32 v230, 0
    v_mov_b32 v231, 0
    v_mov_b32 v232, 0
    v_mov_b32 v233, 0
    v_mov_b32 v234, 0
    v_mov_b32 v235, 0
    v_mov_b32 v236, 0
    v_mov_b32 v237, 0
    v_mov_b32 v238, 0
    v_mov_b32 v239, 0
    v_mov_b32 v240, 0
    v_mov_b32 v241, 0
    v_mov_b32 v242, 0
    v_mov_b32 v243, 0
    v_mov_b32 v244, 0
    v_mov_b32 v245, 0
    v_mov_b32 v246, 0
    v_mov_b32 v247, 0
    v_mov_b32 v248, 0
    v_mov_b32 v249, 0
    v_mov_b32 v250, 0
    v_mov_b32 v251, 0
    v_mov_b32 v252, 0
    v_mov_b32 v253, 0
    v_mov_b32 v254, 0
    v_mov_b32 v255, 0
    s_mov_b32 s12, 0
L_fb_main:
    s_add_u32 s13, s12, 4096
    buffer_load_dwordx4 a[64:67], v1, s[36:39], s12 offen offset:0
    buffer_load_dwordx4 a[68:71], v1, s[36:39], s12 offen offset:64
    buffer_load_dwordx4 a[72:75], v1, s[36:39], s12 offen offset:128
    buffer_load_dwordx4 a[76:79], v1, s[36:39], s12 offen offset:192
    buffer_load_dwordx4 a[80:83], v1, s[36:39], s13 offen offset:0
    buffer_load_dwordx4 a[84:87], v1, s[36:39], s13 offen offset:64
    buffer_load_dwordx4 a[88:91], v1, s[36:39], s13 offen offset:128
    buffer_load_dwordx4 a[92:95], v1, s[36:39], s13 offen offset:192
    s_add_u32 m0, s16, 0
    s_nop 0
    buffer_load_dwordx4 v22, s[40:43], s12 offen offset:0 lds
    buffer_load_dwordx4 v23, s[40:43], s12 offen offset:1024 lds
    buffer_load_dwordx4 v22, s[40:43], s12 offen offset:2048 lds
    buffer_load_dwordx4 v23, s[40:43], s12 offen offset:3072 lds
    s_add_u32 m0, s16, 4096
    s_nop 0
    buffer_load_dwordx4 v22, s[40:43], s13 offen offset:0 lds
    buffer_load_dwordx4 v23, s[40:43], s13 offen offset:1024 lds
    buffer_load_dwordx4 v22, s[40:43], s13 offen offset:2048 lds
    buffer_load_dwordx4 v23, s[40:43], s13 offen offset:3072 lds
    s_waitcnt vmcnt(0)
    ds_read_b64_tr_b16 a[128:129], v104 offset:0
    ds_read_b64_tr_b16 a[130:131], v104 offset:4096
    ds_read_b64_tr_b16 a[132:133], v105 offset:0
    ds_read_b64_tr_b16 a[134:135], v105 offset:4096
    ds_read_b64_tr_b16 a[136:137], v106 offset:0
    ds_read_b64_tr_b16 a[138:139], v106 offset:4096
    ds_read_b64_tr_b16 a[140:141], v107 offset:0
    ds_read_b64_tr_b16 a[142:143], v107 offset:4096
    ds_read_b64_tr_b16 a[144:145], v108 offset:0
    ds_read_b64_tr_b16 a[146:147], v108 offset:4096
    ds_read_b64_tr_b16 a[148:149], v109 offset:0
    ds_read_b64_tr_b16 a[150:151], v109 offset:4096
    ds_read_b64_tr_b16 a[152:153], v110 offset:0
    ds_read_b64_tr_b16 a[154:155], v110 offset:4096
    ds_read_b64_tr_b16 a[156:157], v111 offset:0
    ds_read_b64_tr_b16 a[158:159], v111 offset:4096
    s_waitcnt lgkmcnt(0)
    v_mfma_f32_16x16x32_bf16 v[64:67], a[64:67], a[0:3], v[48:51]
    v_mfma_f32_16x16x32_bf16 v[64:67], a[68:71], a[4:7], v[64:67]
    v_mfma_f32_16x16x32_bf16 v[64:67], a[72:75], a[8:11], v[64:67]
    v_mfma_f32_16x16x32_bf16 v[64:67], a[76:79], a[12:15], v[64:67]
    v_mfma_f32_16x16x32_bf16 v[68:71], a[80:83], a[0:3], v[48:51]
    v_mfma_f32_16x16x32_bf16 v[68:71], a[84:87], a[4:7], v[68:71]
    v_mfma_f32_16x16x32_bf16 v[68:71], a[88:91], a[8:11], v[68:71]
    v_mfma_f32_16x16x32_bf16 v[68:71], a[92:95], a[12:15], v[68:71]
    s_nop 3
    v_exp_f32 v64, v64
    v_exp_f32 v65, v65
    v_exp_f32 v66, v66
    v_exp_f32 v67, v67
    v_exp_f32 v68, v68
    v_exp_f32 v69, v69
    v_exp_f32 v70, v70
    v_exp_f32 v71, v71
    v_add_f32 v26, v26, v64
    v_add_f32 v26, v26, v65
    v_add_f32 v26, v26, v66
    v_add_f32 v26, v26, v67
    v_add_f32 v26, v26, v68
    v_add_f32 v26, v26, v69
    v_add_f32 v26, v26, v70
    v_add_f32 v26, v26, v71
    v_cvt_pk_bf16_f32 v80, v64, v65
    v_cvt_pk_bf16_f32 v81, v66, v67
    v_cvt_pk_bf16_f32 v82, v68, v69
    v_cvt_pk_bf16_f32 v83, v70, v71
    s_nop 1
    v_mfma_f32_16x16x32_bf16 v[128:131], a[128:131], v[80:83], v[128:131]
    v_mfma_f32_16x16x32_bf16 v[132:135], a[132:135], v[80:83], v[132:135]
    v_mfma_f32_16x16x32_bf16 v[136:139], a[136:139], v[80:83], v[136:139]
    v_mfma_f32_16x16x32_bf16 v[140:143], a[140:143], v[80:83], v[140:143]
    v_mfma_f32_16x16x32_bf16 v[144:147], a[144:147], v[80:83], v[144:147]
    v_mfma_f32_16x16x32_bf16 v[148:151], a[148:151], v[80:83], v[148:151]
    v_mfma_f32_16x16x32_bf16 v[152:155], a[152:155], v[80:83], v[152:155]
    v_mfma_f32_16x16x32_bf16 v[156:159], a[156:159], v[80:83], v[156:159]
    v_mfma_f32_16x16x32_bf16 v[72:75], a[64:67], a[16:19], v[52:55]
    v_mfma_f32_16x16x32_bf16 v[72:75], a[68:71], a[20:23], v[72:75]
    v_mfma_f32_16x16x32_bf16 v[72:75], a[72:75], a[24:27], v[72:75]
    v_mfma_f32_16x16x32_bf16 v[72:75], a[76:79], a[28:31], v[72:75]
    v_mfma_f32_16x16x32_bf16 v[76:79], a[80:83], a[16:19], v[52:55]
    v_mfma_f32_16x16x32_bf16 v[76:79], a[84:87], a[20:23], v[76:79]
    v_mfma_f32_16x16x32_bf16 v[76:79], a[88:91], a[24:27], v[76:79]
    v_mfma_f32_16x16x32_bf16 v[76:79], a[92:95], a[28:31], v[76:79]
    s_nop 3
    v_exp_f32 v72, v72
    v_exp_f32 v73, v73
    v_exp_f32 v74, v74
    v_exp_f32 v75, v75
    v_exp_f32 v76, v76
    v_exp_f32 v77, v77
    v_exp_f32 v78, v78
    v_exp_f32 v79, v79
    v_add_f32 v27, v27, v72
    v_add_f32 v27, v27, v73
    v_add_f32 v27, v27, v74
    v_add_f32 v27, v27, v75
    v_add_f32 v27, v27, v76
    v_add_f32 v27, v27, v77
    v_add_f32 v27, v27, v78
    v_add_f32 v27, v27, v79
    v_cvt_pk_bf16_f32 v84, v72, v73
    v_cvt_pk_bf16_f32 v85, v74, v75
    v_cvt_pk_bf16_f32 v86, v76, v77
    v_cvt_pk_bf16_f32 v87, v78, v79
    s_nop 1
    v_mfma_f32_16x16x32_bf16 v[160:163], a[128:131], v[84:87], v[160:163]
    v_mfma_f32_16x16x32_bf16 v[164:167], a[132:135], v[84:87], v[164:167]
    v_mfma_f32_16x16x32_bf16 v[168:171], a[136:139], v[84:87], v[168:171]
    v_mfma_f32_16x16x32_bf16 v[172:175], a[140:143], v[84:87], v[172:175]
    v_mfma_f32_16x16x32_bf16 v[176:179], a[144:147], v[84:87], v[176:179]
    v_mfma_f32_16x16x32_bf16 v[180:183], a[148:151], v[84:87], v[180:183]
    v_mfma_f32_16x16x32_bf16 v[184:187], a[152:155], v[84:87], v[184:187]
    v_mfma_f32_16x16x32_bf16 v[188:191], a[156:159], v[84:87], v[188:191]
    v_mfma_f32_16x16x32_bf16 v[64:67], a[64:67], a[32:35], v[56:59]
    v_mfma_f32_16x16x32_bf16 v[64:67], a[68:71], a[36:39], v[64:67]
    v_mfma_f32_16x16x32_bf16 v[64:67], a[72:75], a[40:43], v[64:67]
    v_mfma_f32_16x16x32_bf16 v[64:67], a[76:79], a[44:47], v[64:67]
    v_mfma_f32_16x16x32_bf16 v[68:71], a[80:83], a[32:35], v[56:59]
    v_mfma_f32_16x16x32_bf16 v[68:71], a[84:87], a[36:39], v[68:71]
    v_mfma_f32_16x16x32_bf16 v[68:71], a[88:91], a[40:43], v[68:71]
    v_mfma_f32_16x16x32_bf16 v[68:71], a[92:95], a[44:47], v[68:71]
    s_nop 3
    v_exp_f32 v64, v64
    v_exp_f32 v65, v65
    v_exp_f32 v66, v66
    v_exp_f32 v67, v67
    v_exp_f32 v68, v68
    v_exp_f32 v69, v69
    v_exp_f32 v70, v70
    v_exp_f32 v71, v71
    v_add_f32 v28, v28, v64
    v_add_f32 v28, v28, v65
    v_add_f32 v28, v28, v66
    v_add_f32 v28, v28, v67
    v_add_f32 v28, v28, v68
    v_add_f32 v28, v28, v69
    v_add_f32 v28, v28, v70
    v_add_f32 v28, v28, v71
    v_cvt_pk_bf16_f32 v88, v64, v65
    v_cvt_pk_bf16_f32 v89, v66, v67
    v_cvt_pk_bf16_f32 v90, v68, v69
    v_cvt_pk_bf16_f32 v91, v70, v71
    s_nop 1
    v_mfma_f32_16x16x32_bf16 v[192:195], a[128:131], v[88:91], v[192:195]
    v_mfma_f32_16x16x32_bf16 v[196:199], a[132:135], v[88:91], v[196:199]
    v_mfma_f32_16x16x32_bf16 v[200:203], a[136:139], v[88:91], v[200:203]
    v_mfma_f32_16x16x32_bf16 v[204:207], a[140:143], v[88:91], v[204:207]
    v_mfma_f32_16x16x32_bf16 v[208:211], a[144:147], v[88:91], v[208:211]
    v_mfma_f32_16x16x32_bf16 v[212:215], a[148:151], v[88:91], v[212:215]
    v_mfma_f32_16x16x32_bf16 v[216:219], a[152:155], v[88:91], v[216:219]
    v_mfma_f32_16x16x32_bf16 v[220:223], a[156:159], v[88:91], v[220:223]
    v_mfma_f32_16x16x32_bf16 v[72:75], a[64:67], a[48:51], v[60:63]
    v_mfma_f32_16x16x32_bf16 v[72:75], a[68:71], a[52:55], v[72:75]
    v_mfma_f32_16x16x32_bf16 v[72:75], a[72:75], a[56:59], v[72:75]
    v_mfma_f32_16x16x32_bf16 v[72:75], a[76:79], a[60:63], v[72:75]
    v_mfma_f32_16x16x32_bf16 v[76:79], a[80:83], a[48:51], v[60:63]
    v_mfma_f32_16x16x32_bf16 v[76:79], a[84:87], a[52:55], v[76:79]
    v_mfma_f32_16x16x32_bf16 v[76:79], a[88:91], a[56:59], v[76:79]
    v_mfma_f32_16x16x32_bf16 v[76:79], a[92:95], a[60:63], v[76:79]
    s_nop 3
    v_exp_f32 v72, v72
    v_exp_f32 v73, v73
    v_exp_f32 v74, v74
    v_exp_f32 v75, v75
    v_exp_f32 v76, v76
    v_exp_f32 v77, v77
    v_exp_f32 v78, v78
    v_exp_f32 v79, v79
    v_add_f32 v29, v29, v72
    v_add_f32 v29, v29, v73
    v_add_f32 v29, v29, v74
    v_add_f32 v29, v29, v75
    v_add_f32 v29, v29, v76
    v_add_f32 v29, v29, v77
    v_add_f32 v29, v29, v78
    v_add_f32 v29, v29, v79
    v_cvt_pk_bf16_f32 v92, v72, v73
    v_cvt_pk_bf16_f32 v93, v74, v75
    v_cvt_pk_bf16_f32 v94, v76, v77
    v_cvt_pk_bf16_f32 v95, v78, v79
    s_nop 1
    v_mfma_f32_16x16x32_bf16 v[224:227], a[128:131], v[92:95], v[224:227]
    v_mfma_f32_16x16x32_bf16 v[228:231], a[132:135], v[92:95], v[228:231]
    v_mfma_f32_16x16x32_bf16 v[232:235], a[136:139], v[92:95], v[232:235]
    v_mfma_f32_16x16x32_bf16 v[236:239], a[140:143], v[92:95], v[236:239]
    v_mfma_f32_16x16x32_bf16 v[240:243], a[144:147], v[92:95], v[240:243]
    v_mfma_f32_16x16x32_bf16 v[244:247], a[148:151], v[92:95], v[244:247]
    v_mfma_f32_16x16x32_bf16 v[248:251], a[152:155], v[92:95], v[248:251]
    v_mfma_f32_16x16x32_bf16 v[252:255], a[156:159], v[92:95], v[252:255]
    s_add_u32 s12, s12, 8192
    s_cmp_lt_u32 s12, 0x20000
    s_nop 7
    s_cbranch_scc1 L_fb_main
    v_mov_b32 v31, v26
    s_nop 1
    v_permlane16_swap_b32 v26, v31
    v_add_f32 v26, v26, v31
    v_mov_b32 v31, v26
    s_nop 1
    v_permlane32_swap_b32 v26, v31
    v_add_f32 v26, v26, v31
    v_rcp_f32 v30, v26
    s_xor_b32 s32, s67, 0
    v_mul_f32 v128, v30, v128
    v_mul_f32 v129, v30, v129
    v_mul_f32 v130, v30, v130
    v_mul_f32 v131, v30, v131
    v_cvt_pk_bf16_f32 v128, v128, v129
    v_cvt_pk_bf16_f32 v129, v130, v131
    v_mul_f32 v132, v30, v132
    v_mul_f32 v133, v30, v133
    v_mul_f32 v134, v30, v134
    v_mul_f32 v135, v30, v135
    v_cvt_pk_bf16_f32 v132, v132, v133
    v_cvt_pk_bf16_f32 v133, v134, v135
    v_mul_f32 v136, v30, v136
    v_mul_f32 v137, v30, v137
    v_mul_f32 v138, v30, v138
    v_mul_f32 v139, v30, v139
    v_cvt_pk_bf16_f32 v136, v136, v137
    v_cvt_pk_bf16_f32 v137, v138, v139
    v_mul_f32 v140, v30, v140
    v_mul_f32 v141, v30, v141
    v_mul_f32 v142, v30, v142
    v_mul_f32 v143, v30, v143
    v_cvt_pk_bf16_f32 v140, v140, v141
    v_cvt_pk_bf16_f32 v141, v142, v143
    v_mul_f32 v144, v30, v144
    v_mul_f32 v145, v30, v145
    v_mul_f32 v146, v30, v146
    v_mul_f32 v147, v30, v147
    v_cvt_pk_bf16_f32 v144, v144, v145
    v_cvt_pk_bf16_f32 v145, v146, v147
    v_mul_f32 v148, v30, v148
    v_mul_f32 v149, v30, v149
    v_mul_f32 v150, v30, v150
    v_mul_f32 v151, v30, v151
    v_cvt_pk_bf16_f32 v148, v148, v149
    v_cvt_pk_bf16_f32 v149, v150, v151
    v_mul_f32 v152, v30, v152
    v_mul_f32 v153, v30, v153
    v_mul_f32 v154, v30, v154
    v_mul_f32 v155, v30, v155
    v_cvt_pk_bf16_f32 v152, v152, v153
    v_cvt_pk_bf16_f32 v153, v154, v155
    v_mul_f32 v156, v30, v156
    v_mul_f32 v157, v30, v157
    v_mul_f32 v158, v30, v158
    v_mul_f32 v159, v30, v159
    v_cvt_pk_bf16_f32 v156, v156, v157
    v_cvt_pk_bf16_f32 v157, v158, v159
    ds_write2_b64 v40, v[128:129], v[132:133] offset0:0 offset1:4
    ds_write2_b64 v40, v[136:137], v[140:141] offset0:8 offset1:12
    ds_write2_b64 v41, v[144:145], v[148:149] offset0:0 offset1:4
    ds_write2_b64 v41, v[152:153], v[156:157] offset0:8 offset1:12
    ds_read2_b64 v[128:131], v42 offset0:0 offset1:1
    ds_read2_b64 v[132:135], v42 offset0:136 offset1:137
    ds_read2_b64 v[144:147], v43 offset0:0 offset1:1
    ds_read2_b64 v[148:151], v43 offset0:136 offset1:137
    s_waitcnt lgkmcnt(0)
    buffer_store_dwordx4 v[128:131], v44, s[32:35], 0 offen offset:0 sc1
    buffer_store_dwordx4 v[132:135], v44, s[32:35], 0 offen offset:2048 sc1
    buffer_store_dwordx4 v[144:147], v44, s[32:35], 0 offen offset:128 sc1
    buffer_store_dwordx4 v[148:151], v44, s[32:35], 0 offen offset:2176 sc1
    v_mov_b32 v33, v27
    s_nop 1
    v_permlane16_swap_b32 v27, v33
    v_add_f32 v27, v27, v33
    v_mov_b32 v33, v27
    s_nop 1
    v_permlane32_swap_b32 v27, v33
    v_add_f32 v27, v27, v33
    v_rcp_f32 v32, v27
    s_xor_b32 s32, s67, 4096
    v_mul_f32 v160, v32, v160
    v_mul_f32 v161, v32, v161
    v_mul_f32 v162, v32, v162
    v_mul_f32 v163, v32, v163
    v_cvt_pk_bf16_f32 v160, v160, v161
    v_cvt_pk_bf16_f32 v161, v162, v163
    v_mul_f32 v164, v32, v164
    v_mul_f32 v165, v32, v165
    v_mul_f32 v166, v32, v166
    v_mul_f32 v167, v32, v167
    v_cvt_pk_bf16_f32 v164, v164, v165
    v_cvt_pk_bf16_f32 v165, v166, v167
    v_mul_f32 v168, v32, v168
    v_mul_f32 v169, v32, v169
    v_mul_f32 v170, v32, v170
    v_mul_f32 v171, v32, v171
    v_cvt_pk_bf16_f32 v168, v168, v169
    v_cvt_pk_bf16_f32 v169, v170, v171
    v_mul_f32 v172, v32, v172
    v_mul_f32 v173, v32, v173
    v_mul_f32 v174, v32, v174
    v_mul_f32 v175, v32, v175
    v_cvt_pk_bf16_f32 v172, v172, v173
    v_cvt_pk_bf16_f32 v173, v174, v175
    v_mul_f32 v176, v32, v176
    v_mul_f32 v177, v32, v177
    v_mul_f32 v178, v32, v178
    v_mul_f32 v179, v32, v179
    v_cvt_pk_bf16_f32 v176, v176, v177
    v_cvt_pk_bf16_f32 v177, v178, v179
    v_mul_f32 v180, v32, v180
    v_mul_f32 v181, v32, v181
    v_mul_f32 v182, v32, v182
    v_mul_f32 v183, v32, v183
    v_cvt_pk_bf16_f32 v180, v180, v181
    v_cvt_pk_bf16_f32 v181, v182, v183
    v_mul_f32 v184, v32, v184
    v_mul_f32 v185, v32, v185
    v_mul_f32 v186, v32, v186
    v_mul_f32 v187, v32, v187
    v_cvt_pk_bf16_f32 v184, v184, v185
    v_cvt_pk_bf16_f32 v185, v186, v187
    v_mul_f32 v188, v32, v188
    v_mul_f32 v189, v32, v189
    v_mul_f32 v190, v32, v190
    v_mul_f32 v191, v32, v191
    v_cvt_pk_bf16_f32 v188, v188, v189
    v_cvt_pk_bf16_f32 v189, v190, v191
    ds_write2_b64 v40, v[160:161], v[164:165] offset0:0 offset1:4
    ds_write2_b64 v40, v[168:169], v[172:173] offset0:8 offset1:12
    ds_write2_b64 v41, v[176:177], v[180:181] offset0:0 offset1:4
    ds_write2_b64 v41, v[184:185], v[188:189] offset0:8 offset1:12
    ds_read2_b64 v[160:163], v42 offset0:0 offset1:1
    ds_read2_b64 v[164:167], v42 offset0:136 offset1:137
    ds_read2_b64 v[176:179], v43 offset0:0 offset1:1
    ds_read2_b64 v[180:183], v43 offset0:136 offset1:137
    s_waitcnt lgkmcnt(0)
    buffer_store_dwordx4 v[160:163], v44, s[32:35], 0 offen offset:0 sc1
    buffer_store_dwordx4 v[164:167], v44, s[32:35], 0 offen offset:2048 sc1
    buffer_store_dwordx4 v[176:179], v44, s[32:35], 0 offen offset:128 sc1
    buffer_store_dwordx4 v[180:183], v44, s[32:35], 0 offen offset:2176 sc1
    v_mov_b32 v35, v28
    s_nop 1
    v_permlane16_swap_b32 v28, v35
    v_add_f32 v28, v28, v35
    v_mov_b32 v35, v28
    s_nop 1
    v_permlane32_swap_b32 v28, v35
    v_add_f32 v28, v28, v35
    v_rcp_f32 v34, v28
    s_xor_b32 s32, s67, 8192
    v_mul_f32 v192, v34, v192
    v_mul_f32 v193, v34, v193
    v_mul_f32 v194, v34, v194
    v_mul_f32 v195, v34, v195
    v_cvt_pk_bf16_f32 v192, v192, v193
    v_cvt_pk_bf16_f32 v193, v194, v195
    v_mul_f32 v196, v34, v196
    v_mul_f32 v197, v34, v197
    v_mul_f32 v198, v34, v198
    v_mul_f32 v199, v34, v199
    v_cvt_pk_bf16_f32 v196, v196, v197
    v_cvt_pk_bf16_f32 v197, v198, v199
    v_mul_f32 v200, v34, v200
    v_mul_f32 v201, v34, v201
    v_mul_f32 v202, v34, v202
    v_mul_f32 v203, v34, v203
    v_cvt_pk_bf16_f32 v200, v200, v201
    v_cvt_pk_bf16_f32 v201, v202, v203
    v_mul_f32 v204, v34, v204
    v_mul_f32 v205, v34, v205
    v_mul_f32 v206, v34, v206
    v_mul_f32 v207, v34, v207
    v_cvt_pk_bf16_f32 v204, v204, v205
    v_cvt_pk_bf16_f32 v205, v206, v207
    v_mul_f32 v208, v34, v208
    v_mul_f32 v209, v34, v209
    v_mul_f32 v210, v34, v210
    v_mul_f32 v211, v34, v211
    v_cvt_pk_bf16_f32 v208, v208, v209
    v_cvt_pk_bf16_f32 v209, v210, v211
    v_mul_f32 v212, v34, v212
    v_mul_f32 v213, v34, v213
    v_mul_f32 v214, v34, v214
    v_mul_f32 v215, v34, v215
    v_cvt_pk_bf16_f32 v212, v212, v213
    v_cvt_pk_bf16_f32 v213, v214, v215
    v_mul_f32 v216, v34, v216
    v_mul_f32 v217, v34, v217
    v_mul_f32 v218, v34, v218
    v_mul_f32 v219, v34, v219
    v_cvt_pk_bf16_f32 v216, v216, v217
    v_cvt_pk_bf16_f32 v217, v218, v219
    v_mul_f32 v220, v34, v220
    v_mul_f32 v221, v34, v221
    v_mul_f32 v222, v34, v222
    v_mul_f32 v223, v34, v223
    v_cvt_pk_bf16_f32 v220, v220, v221
    v_cvt_pk_bf16_f32 v221, v222, v223
    ds_write2_b64 v40, v[192:193], v[196:197] offset0:0 offset1:4
    ds_write2_b64 v40, v[200:201], v[204:205] offset0:8 offset1:12
    ds_write2_b64 v41, v[208:209], v[212:213] offset0:0 offset1:4
    ds_write2_b64 v41, v[216:217], v[220:221] offset0:8 offset1:12
    ds_read2_b64 v[192:195], v42 offset0:0 offset1:1
    ds_read2_b64 v[196:199], v42 offset0:136 offset1:137
    ds_read2_b64 v[208:211], v43 offset0:0 offset1:1
    ds_read2_b64 v[212:215], v43 offset0:136 offset1:137
    s_waitcnt lgkmcnt(0)
    buffer_store_dwordx4 v[192:195], v44, s[32:35], 0 offen offset:0 sc1
    buffer_store_dwordx4 v[196:199], v44, s[32:35], 0 offen offset:2048 sc1
    buffer_store_dwordx4 v[208:211], v44, s[32:35], 0 offen offset:128 sc1
    buffer_store_dwordx4 v[212:215], v44, s[32:35], 0 offen offset:2176 sc1
    v_mov_b32 v37, v29
    s_nop 1
    v_permlane16_swap_b32 v29, v37
    v_add_f32 v29, v29, v37
    v_mov_b32 v37, v29
    s_nop 1
    v_permlane32_swap_b32 v29, v37
    v_add_f32 v29, v29, v37
    v_rcp_f32 v36, v29
    s_xor_b32 s32, s67, 12288
    v_mul_f32 v224, v36, v224
    v_mul_f32 v225, v36, v225
    v_mul_f32 v226, v36, v226
    v_mul_f32 v227, v36, v227
    v_cvt_pk_bf16_f32 v224, v224, v225
    v_cvt_pk_bf16_f32 v225, v226, v227
    v_mul_f32 v228, v36, v228
    v_mul_f32 v229, v36, v229
    v_mul_f32 v230, v36, v230
    v_mul_f32 v231, v36, v231
    v_cvt_pk_bf16_f32 v228, v228, v229
    v_cvt_pk_bf16_f32 v229, v230, v231
    v_mul_f32 v232, v36, v232
    v_mul_f32 v233, v36, v233
    v_mul_f32 v234, v36, v234
    v_mul_f32 v235, v36, v235
    v_cvt_pk_bf16_f32 v232, v232, v233
    v_cvt_pk_bf16_f32 v233, v234, v235
    v_mul_f32 v236, v36, v236
    v_mul_f32 v237, v36, v237
    v_mul_f32 v238, v36, v238
    v_mul_f32 v239, v36, v239
    v_cvt_pk_bf16_f32 v236, v236, v237
    v_cvt_pk_bf16_f32 v237, v238, v239
    v_mul_f32 v240, v36, v240
    v_mul_f32 v241, v36, v241
    v_mul_f32 v242, v36, v242
    v_mul_f32 v243, v36, v243
    v_cvt_pk_bf16_f32 v240, v240, v241
    v_cvt_pk_bf16_f32 v241, v242, v243
    v_mul_f32 v244, v36, v244
    v_mul_f32 v245, v36, v245
    v_mul_f32 v246, v36, v246
    v_mul_f32 v247, v36, v247
    v_cvt_pk_bf16_f32 v244, v244, v245
    v_cvt_pk_bf16_f32 v245, v246, v247
    v_mul_f32 v248, v36, v248
    v_mul_f32 v249, v36, v249
    v_mul_f32 v250, v36, v250
    v_mul_f32 v251, v36, v251
    v_cvt_pk_bf16_f32 v248, v248, v249
    v_cvt_pk_bf16_f32 v249, v250, v251
    v_mul_f32 v252, v36, v252
    v_mul_f32 v253, v36, v253
    v_mul_f32 v254, v36, v254
    v_mul_f32 v255, v36, v255
    v_cvt_pk_bf16_f32 v252, v252, v253
    v_cvt_pk_bf16_f32 v253, v254, v255
    ds_write2_b64 v40, v[224:225], v[228:229] offset0:0 offset1:4
    ds_write2_b64 v40, v[232:233], v[236:237] offset0:8 offset1:12
    ds_write2_b64 v41, v[240:241], v[244:245] offset0:0 offset1:4
    ds_write2_b64 v41, v[248:249], v[252:253] offset0:8 offset1:12
    ds_read2_b64 v[224:227], v42 offset0:0 offset1:1
    ds_read2_b64 v[228:231], v42 offset0:136 offset1:137
    ds_read2_b64 v[240:243], v43 offset0:0 offset1:1
    ds_read2_b64 v[244:247], v43 offset0:136 offset1:137
    s_waitcnt lgkmcnt(0)
    buffer_store_dwordx4 v[224:227], v44, s[32:35], 0 offen offset:0 sc1
    buffer_store_dwordx4 v[228:231], v44, s[32:35], 0 offen offset:2048 sc1
    buffer_store_dwordx4 v[240:243], v44, s[32:35], 0 offen offset:128 sc1
    buffer_store_dwordx4 v[244:247], v44, s[32:35], 0 offen offset:2176 sc1
    s_endpgm
.section .rodata,"a"
.p2align 6
.amdhsa_kernel standalone__gqa_softmax__near_ridge_kernel
  .amdhsa_next_free_vgpr 512
  .amdhsa_next_free_sgpr 102
  .amdhsa_accum_offset 256
  .amdhsa_group_segment_fixed_size 0
  .amdhsa_float_denorm_mode_32 3
  .amdhsa_kernarg_size 48
  .amdhsa_user_sgpr_count 2
  .amdhsa_user_sgpr_kernarg_segment_ptr 1
  .amdhsa_system_sgpr_workgroup_id_x 1
.end_amdhsa_kernel
```
